```python
import torch

def _softmax(x, axis=-1):
    return torch.softmax(x, dim=axis)
def _gelu(x):
    return torch.nn.functional.gelu(x, approximate="tanh")
def _silu(x):
    return torch.nn.functional.silu(x)
def _sigmoid(x):
    return torch.sigmoid(x)
def _layernorm(x, axis=-1, eps=1e-5):
    m = x.mean(dim=axis, keepdim=True)
    v = x.var(dim=axis, keepdim=True, unbiased=False)
    return (x - m) / torch.sqrt(v + eps)
def _scatter_add(tgt, idx, src, axis=0):
    return tgt.clone().index_add_(axis, idx, src)
def _segment_sum(src, seg, n):
    out = torch.zeros((n,) + src.shape[1:], dtype=src.dtype)
    return out.index_add_(0, seg, src)
def _pad(x, pw):
    flat = tuple(v for pair in reversed(pw) for v in pair)
    return torch.nn.functional.pad(x, flat)

kernel_name = 'concat_heads__ssm_conv_h3__ssm_conv_s4__prompt'

def setup_inputs():

    _w = (lambda a: (lambda t: t.to(torch.bfloat16) if t.is_floating_point() else t)(torch.as_tensor(a)))
    def _A_setup():
        B, S, D = 1, 2048, 640
        ks = 4
        return {
            "q": _w((lambda *s: torch.randn(*s, dtype=torch.bfloat16) * 0.05)(B, S, D)),
            "k": _w((lambda *s: torch.randn(*s, dtype=torch.bfloat16) * 0.2)(B, S, D)),
            "v": _w((lambda *s: torch.randn(*s, dtype=torch.bfloat16) * 0.2)(B, S, D)),
            "shift_k": _w((lambda *s: torch.randn(*s, dtype=torch.bfloat16) * 0.2)(D, ks) * 0.5),
            "ssm_k": _w((lambda *s: torch.randn(*s, dtype=torch.bfloat16) * 0.8)(D, S) * (1.0 / S ** 0.5)),
            "ssm_D": _w((lambda *s: torch.randn(*s, dtype=torch.bfloat16) * 0.2)(D)),
        }
    _A_in = _A_setup()

    def _B_setup():
        B, L, D, N = 1, 2048, 640, 192
        A_re = -(lambda _x: torch.exp(torch.as_tensor(_x)))((lambda *s: torch.randn(*s, dtype=torch.bfloat16) * 3.2)(D, N))
        A_im = torch.pi * (lambda *s: torch.randn(*s, dtype=torch.bfloat16) * 0.05)(D, N)
        B_re = (lambda *s: torch.randn(*s, dtype=torch.bfloat16) * 0.1)(D, N)
        B_im = (lambda *s: torch.randn(*s, dtype=torch.bfloat16) * 0.1)(D, N)
        C_re = (lambda *s: torch.randn(*s, dtype=torch.bfloat16) * 0.1)(D, N)
        C_im = (lambda *s: torch.randn(*s, dtype=torch.bfloat16) * 0.1)(D, N)
        log_dt = (lambda *s: torch.randn(*s, dtype=torch.bfloat16) * 0.05)(D) * 0.5 - 4.0
        Dskip = (lambda *s: torch.randn(*s, dtype=torch.bfloat16) * 0.05)(D)
        return {
            "u": _w((lambda *s: torch.randn(*s, dtype=torch.bfloat16) * 0.05)(B, L, D)),
            "A_re": _w(A_re),
            "A_im": _w(A_im),
            "B_re": _w(B_re),
            "B_im": _w(B_im),
            "C_re": _w(C_re),
            "C_im": _w(C_im),
            "log_dt": _w(log_dt),
            "Dskip": _w(Dskip),
        }
    _B_in = _B_setup()

    return {
        "A_q": _A_in["q"],
        "A_k": _A_in["k"],
        "A_v": _A_in["v"],
        "A_shift_k": _A_in["shift_k"],
        "A_ssm_k": _A_in["ssm_k"],
        "A_ssm_D": _A_in["ssm_D"],
        "B_u": _B_in["u"],
        "B_A_re": _B_in["A_re"],
        "B_A_im": _B_in["A_im"],
        "B_B_re": _B_in["B_re"],
        "B_B_im": _B_in["B_im"],
        "B_C_re": _B_in["C_re"],
        "B_C_im": _B_in["C_im"],
        "B_log_dt": _B_in["log_dt"],
        "B_Dskip": _B_in["Dskip"],
    }

def reference(A_q, A_k, A_v, A_shift_k, A_ssm_k, A_ssm_D, B_u, B_A_re, B_A_im, B_B_re, B_B_im, B_C_re, B_C_im, B_log_dt, B_Dskip):
    def _A_ref(q, k, v, shift_k, ssm_k, ssm_D):
        B, S, D = q.shape
        ks = shift_k.shape[-1]
        k_pad = _pad(k, ((0, 0), (ks - 1, 0), (0, 0)))
        k_shift = torch.zeros_like(k)
        for t in range(ks):
            k_shift = k_shift + k_pad[:, t:t + S, :] * shift_k[:, ks - 1 - t][None, None, :]
        kv = k_shift * v
        L = 2 * S
        kv_pad = _pad(kv, ((0, 0), (0, S), (0, 0)))
        kf_pad = _pad(ssm_k, ((0, 0), (0, S)))
        kv_f = (lambda x, axes=(-2,-1): torch.fft.rfft2(x.float(), dim=axes))(kv_pad[:, None, :, :], axes=(1, 2))
        kf_f = (lambda x, axes=(-2,-1): torch.fft.rfft2(x.float(), dim=axes))(kf_pad[:, None, :], axes=(1, 2))
        kf_f = (lambda x, *d: x.permute(*d))(kf_f, 1, 2, 0)
        y_f = kv_f * kf_f[None, :, :, :]
        y = (lambda x, s, axes=(-2,-1): torch.fft.irfft2(x, s=s, dim=axes).to(torch.bfloat16))(y_f, (1, L), axes=(1, 2))[:, 0, :S, :]
        y = y + kv * ssm_D[None, None, :]
        return q * y

    def _B_ref(u, A_re, A_im, B_re, B_im, C_re, C_im, log_dt, Dskip):
        Bsz, L, D = u.shape
        dt = torch.exp(log_dt)[:, None]
        A = A_re + 1j * A_im
        Bc = B_re + 1j * B_im
        Cc = C_re + 1j * C_im
        logdA = dt * A
        dB = dt * Bc
        l = (lambda x, dt: x.to(dt))(torch.arange(L), A_re.dtype)
        P = torch.exp(logdA[:, :, None] * l[None, None, :])
        K = torch.einsum("dn,dnl,dn->dl", Cc, P, dB).real
        L2 = 2 * L
        Kp = _pad(K, ((0, 0), (0, L)))
        up = (lambda x, *d: x.permute(*d))(u, 0, 2, 1)
        up = _pad(up, ((0, 0), (0, 0), (0, L)))
        Kf = (lambda x, axes=(-2,-1): torch.fft.rfft2(x.float(), dim=axes))(Kp[:, None, :], axes=(-2, -1))
        Uf = (lambda x, axes=(-2,-1): torch.fft.rfft2(x.float(), dim=axes))(up[:, :, None, :], axes=(-2, -1))
        Yf = Uf * Kf[None, :, :, :]
        y = (lambda x, s, axes=(-2,-1): torch.fft.irfft2(x, s=s, dim=axes).to(torch.bfloat16))(Yf, (1, L2), axes=(-2, -1))[:, :, 0, :L]
        y = (lambda x, *d: x.permute(*d))(y, 0, 2, 1) + u * Dskip[None, None, :]
        return y

    a = _A_ref(A_q, A_k, A_v, A_shift_k, A_ssm_k, A_ssm_D)
    b = _B_ref(B_u, B_A_re, B_A_im, B_B_re, B_B_im, B_C_re, B_C_im, B_log_dt, B_Dskip)
    return torch.concatenate([a, b], axis=-1)
```

```asm
; @launch grid=(256,1,1) block=(512,1,1) lds=148416
.amdgcn_target "amdgcn-amd-amdhsa--gfx950"
.text
.globl concat_heads__ssm_conv_h3__ssm_conv_s4__prompt_kernel
.p2align 8
.type concat_heads__ssm_conv_h3__ssm_conv_s4__prompt_kernel,@function
concat_heads__ssm_conv_h3__ssm_conv_s4__prompt_kernel:
    s_load_dwordx16 s[4:19], s[0:1], 0
    s_load_dwordx16 s[20:35], s[0:1], 64
    s_getpc_b64 s[52:53]
    s_cmp_ge_u32 s2, 256
    s_cbranch_scc1 L_end
    v_lshrrev_b32 v2, 6, v0
    s_and_b32 s40, s2, 7
    s_lshr_b32 s41, s2, 3
    v_readfirstlane_b32 s42, v2
    v_and_b32 v1, 63, v0
    s_and_b32 s52, s52, 0xffffff00
    s_sub_u32 s47, s41, 12
    s_cmp_lg_u32 s42, 7
    s_cselect_b32 s47, 99, s47
    s_cmp_ge_u32 s47, 16
    s_cbranch_scc1 Ls_1
    s_mul_i32 s47, s47, 12
    v_add_u32 v18, s47, v1
    v_min_u32 v18, (L_codeend-concat_heads__ssm_conv_h3__ssm_conv_s4__prompt_kernel)/128, v18
    v_lshlrev_b32 v18, 7, v18
    s_mov_b64 exec, 0xfff
    global_load_dword v9, v18, s[52:53]
    s_mov_b64 exec, -1
Ls_1:
    v_and_b32 v10, 15, v1
    v_lshrrev_b32 v11, 4, v1
    s_lshr_b32 s54, s42, 2
    s_lshr_b32 s46, s40, 2
    s_mul_i32 s46, s46, 320
    s_and_b32 s47, s40, 3
    s_cmp_lt_u32 s47, 2
    s_cselect_b32 s100, 12, 8
    s_cselect_b32 s96, 128, 0
    s_cselect_b32 s97, 0, 128
    s_mul_i32 s48, s47, 96
    s_mul_i32 s49, s47, 64
    s_add_u32 s101, s49, 64
    s_sub_u32 s43, s48, 64
    s_cmp_lt_u32 s47, 2
    s_cselect_b32 s101, s48, s101
    s_cselect_b32 s43, s49, s43
    s_add_u32 s101, s101, s46
    s_add_u32 s43, s43, s46
    s_lshl_b32 s48, s41, 3
    s_add_u32 s48, s48, s101
    s_cmp_lt_u32 s41, s100
    s_cbranch_scc1 L_A
    s_sub_u32 s61, s41, s100
    s_lshl_b32 s47, s100, 1
    s_sub_u32 s47, 40, s47
    s_cmp_ge_u32 s61, s47
    s_cbranch_scc1 L_fin
    s_lshr_b32 s101, s101, 6
    s_lshl_b32 s101, s101, 7
    s_lshr_b32 s100, s43, 6
    s_lshl_b32 s100, s100, 7
    s_lshl_b32 s47, s61, 2
    s_add_u32 s43, s43, s47
    s_lshl_b32 s62, s42, 4
    s_add_u32 s62, s62, s61
    s_cmp_ge_u32 s61, 16
    s_cselect_b32 s62, 0x1000, s62
    v_lshrrev_b32 v12, 1, v1
    v_mul_u32_u24 v19, 1280, v12
    v_and_b32 v77, 1, v1
    s_and_b32 s57, s42, 3
    s_add_u32 s48, s43, s57
    s_mul_i32 s49, s48, 384
    s_lshl_b32 s47, s54, 8
    s_add_u32 s49, s49, s47
    v_lshlrev_b32 v12, 1, v1
    v_add_u32 v12, s49, v12
    s_lshl_b32 s47, s48, 1
    v_mov_b32 v15, s47
    s_lshl_b32 s55, s43, 1
    v_mov_b32 v14, s55
    v_mov_b32 v78, 0
    v_mov_b32 v128, 0
    v_mov_b32 v129, 0
    v_mov_b32 v130, 0
    v_mov_b32 v131, 0
    v_mov_b32 v132, 0
    v_mov_b32 v133, 0
    v_mov_b32 v134, 0
    v_mov_b32 v135, 0
    v_mov_b32 v136, 0
    v_mov_b32 v137, 0
    v_mov_b32 v138, 0
    v_mov_b32 v139, 0
    s_waitcnt lgkmcnt(0)
    global_load_short_d16_hi v78, v15, s[30:31]
    global_load_short_d16_hi v128, v12, s[18:19]
    global_load_short_d16_hi v129, v12, s[20:21]
    global_load_short_d16_hi v130, v12, s[22:23]
    global_load_short_d16_hi v131, v12, s[24:25]
    global_load_short_d16_hi v132, v12, s[26:27]
    global_load_short_d16_hi v133, v12, s[28:29]
    s_cmp_lg_u32 s54, 0
    s_cbranch_scc1 Ls_2
    global_load_short_d16_hi v134, v12, s[18:19] offset:128
    global_load_short_d16_hi v135, v12, s[20:21] offset:128
    global_load_short_d16_hi v136, v12, s[22:23] offset:128
    global_load_short_d16_hi v137, v12, s[24:25] offset:128
    global_load_short_d16_hi v138, v12, s[26:27] offset:128
    global_load_short_d16_hi v139, v12, s[28:29] offset:128
Ls_2:
    v_mov_b32 v76, 0
    global_load_short_d16_hi v76, v15, s[32:33]
    s_cmp_ge_u32 s62, 96
    s_cbranch_scc1 Ls_3
    s_bitcmp0_b32 s62, 0
    s_cselect_b64 s[50:51], s[6:7], s[8:9]
    s_lshr_b32 s48, s62, 1
    s_sub_u32 s47, s62, 64
    s_cmp_ge_u32 s62, 64
    s_cselect_b64 s[50:51], s[16:17], s[50:51]
    s_cselect_b32 s48, s47, s48
    s_cselect_b32 s49, s97, s96
    s_cselect_b32 s46, s100, s101
    s_mul_i32 s48, s48, 40960
    s_add_u32 s48, s48, s46
    v_mad_u32_u24 v18, v77, s49, v19
    v_add_u32 v18, s48, v18
    global_load_dword v9, v18, s[50:51]
Ls_3:
    s_branch L_B
L_A:
    s_mov_b32 s43, s48
    s_mul_i32 s44, s42, 4592
    s_mul_i32 s3, s42, 8448
    s_mov_b32 m0, s3
    s_add_u32 s3, s3, 36736
    s_add_u32 s48, s43, s42
    s_lshl_b32 s49, s48, 12
    v_lshlrev_b32 v12, 2, v1
    v_add_u32 v12, s49, v12
    v_and_b32 v13, 3, v1
    v_lshlrev_b32 v14, 4, v13
    s_lshl_b32 s47, s43, 3
    v_add_u32 v14, s47, v14
    s_lshl_b32 s47, s48, 1
    v_mov_b32 v15, s47
    v_mov_b32 v75, 0
    s_waitcnt lgkmcnt(0)
    global_load_dword v102, v12, s[12:13] offset:1536
    global_load_dword v103, v12, s[12:13] offset:1792
    global_load_dword v104, v12, s[12:13] offset:2048
    global_load_dword v105, v12, s[12:13] offset:2304
    global_load_dword v106, v12, s[12:13] offset:2560
    global_load_dword v107, v12, s[12:13] offset:2816
    global_load_dword v108, v12, s[12:13] offset:3072
    global_load_dword v109, v12, s[12:13] offset:3328
    global_load_dword v110, v12, s[12:13] offset:3584
    global_load_dword v111, v12, s[12:13] offset:3840
    global_load_dwordx4 v[76:79], v14, s[10:11]
    global_load_short_d16_hi v75, v15, s[14:15]
    global_load_dword v96, v12, s[12:13] offset:0
    global_load_dword v97, v12, s[12:13] offset:256
    global_load_dword v98, v12, s[12:13] offset:512
    global_load_dword v99, v12, s[12:13] offset:768
    global_load_dword v100, v12, s[12:13] offset:1024
    global_load_dword v101, v12, s[12:13] offset:1280
    v_mov_b32 v12, 0
    v_mov_b32 v13, 0
    v_mov_b32 v14, 0
    v_mov_b32 v15, 0
    v_lshlrev_b32 v16, 4, v1
    v_add_u32 v16, s44, v16
    s_mov_b64 exec, 0x3fffffff
    ds_write_b128 v16, v[12:15] offset:4096
    s_mov_b64 exec, -1
    v_lshlrev_b32 v0, 2, v0
    v_add_u32 v0, 144320, v0
    v_mov_b32 v43, 0
    ds_write_b32 v0, v43
    ds_write_b32 v0, v43 offset:2048
    v_and_b32 v19, 7, v1
    v_mul_u32_u24 v19, 260, v19
    v_add_u32 v19, 144320, v19
    s_waitcnt lgkmcnt(0)
    s_barrier
    s_lshl_b32 s55, s43, 1
    v_lshrrev_b32 v12, 2, v1
    s_lshl_b32 s47, s42, 4
    v_add_u32 v12, s47, v12
    v_mul_u32_u24 v13, 5120, v12
    v_and_b32 v14, 3, v1
    v_lshl_add_u32 v13, v14, 2, v13
    v_add_u32 v16, s55, v13
    v_mul_u32_u24 v13, 9184, v14
    v_lshlrev_b32 v12, 3, v12
    v_sub_u32 v13, v13, v12
    v_add_u32 v18, 1016, v13
    v_not_b32 v12, v10
    v_and_b32 v12, 3, v12
    v_mul_u32_u24 v13, 2114, v12
    v_lshl_add_u32 v14, v11, 3, v10
    v_lshl_add_u32 v13, v14, 1, v13
    s_add_u32 s47, s3, 2
    v_add_u32 v2, s47, v13
    v_lshlrev_b32 v12, 4, v11
    v_lshlrev_b32 v13, 5, v10
    v_sub_u32 v12, v12, v13
    s_add_u32 s47, s44, 480
    v_add_u32 v3, s47, v12
    v_lshlrev_b32 v14, 4, v1
    s_add_u32 s47, s3, 32
    v_add_u32 v8, s47, v14
    v_lshlrev_b32 v13, 5, v10
    v_lshl_add_u32 v12, v11, 3, v13
    s_mul_i32 s47, s42, 576
    s_add_u32 s47, s47, 104320
    v_add_u32 v5, s47, v12
    v_bfe_u32 v12, v1, 2, 2
    v_mul_u32_u24 v12, 576, v12
    v_and_b32 v13, 3, v1
    v_lshl_add_u32 v12, v13, 3, v12
    v_lshl_add_u32 v12, v11, 5, v12
    s_and_b32 s47, s42, 3
    s_lshl_b32 s49, s47, 7
    s_mul_i32 s47, s54, 4608
    s_add_u32 s49, s49, s47
    s_add_u32 s49, s49, 104320
    v_add_u32 v6, s49, v12
    s_lshl_b32 s47, s42, 6
    v_add_u32 v12, s47, v1
    v_mul_u32_u24 v12, 1280, v12
    v_add_u32 v7, s55, v12
    v_mov_b32 v9, 0
    s_waitcnt vmcnt(17)
    v_mov_b32_dpp v119, v102 wave_ror:1 row_mask:0xf bank_mask:0xf
    s_waitcnt vmcnt(16)
    v_mov_b32_dpp v120, v103 wave_ror:1 row_mask:0xf bank_mask:0xf
    s_waitcnt vmcnt(15)
    v_mov_b32_dpp v121, v104 wave_ror:1 row_mask:0xf bank_mask:0xf
    s_waitcnt vmcnt(14)
    v_mov_b32_dpp v122, v105 wave_ror:1 row_mask:0xf bank_mask:0xf
    s_waitcnt vmcnt(13)
    v_mov_b32_dpp v123, v106 wave_ror:1 row_mask:0xf bank_mask:0xf
    s_waitcnt vmcnt(12)
    v_mov_b32_dpp v124, v107 wave_ror:1 row_mask:0xf bank_mask:0xf
    s_waitcnt vmcnt(11)
    v_mov_b32_dpp v125, v108 wave_ror:1 row_mask:0xf bank_mask:0xf
    s_waitcnt vmcnt(10)
    v_mov_b32_dpp v126, v109 wave_ror:1 row_mask:0xf bank_mask:0xf
    s_waitcnt vmcnt(9)
    v_mov_b32_dpp v127, v110 wave_ror:1 row_mask:0xf bank_mask:0xf
    v_mov_b32_dpp v119, v103 wave_shr:1 row_mask:0xf bank_mask:0xf
    v_mov_b32_dpp v120, v104 wave_shr:1 row_mask:0xf bank_mask:0xf
    v_mov_b32_dpp v121, v105 wave_shr:1 row_mask:0xf bank_mask:0xf
    v_mov_b32_dpp v122, v106 wave_shr:1 row_mask:0xf bank_mask:0xf
    v_mov_b32_dpp v123, v107 wave_shr:1 row_mask:0xf bank_mask:0xf
    v_mov_b32_dpp v124, v108 wave_shr:1 row_mask:0xf bank_mask:0xf
    v_mov_b32_dpp v125, v109 wave_shr:1 row_mask:0xf bank_mask:0xf
    v_mov_b32_dpp v126, v110 wave_shr:1 row_mask:0xf bank_mask:0xf
    s_waitcnt vmcnt(8)
    v_mov_b32_dpp v127, v111 wave_shr:1 row_mask:0xf bank_mask:0xf
    v_alignbit_b32 v119, v103, v119, 16
    v_alignbit_b32 v120, v104, v120, 16
    v_alignbit_b32 v121, v105, v121, 16
    v_alignbit_b32 v122, v106, v122, 16
    v_alignbit_b32 v123, v107, v123, 16
    v_alignbit_b32 v124, v108, v124, 16
    v_alignbit_b32 v125, v109, v125, 16
    v_alignbit_b32 v126, v110, v126, 16
    v_alignbit_b32 v127, v111, v127, 16
    s_mov_b32 exec_lo, 0
    s_mov_b32 exec_hi, 0xff000000
    ds_write_addtid_b32 v103 offset:36512
    ds_write_addtid_b32 v119 offset:38624
    ds_write_addtid_b32 v103 offset:40740
    ds_write_addtid_b32 v119 offset:42852
    s_mov_b64 exec, -1
    ds_write_addtid_b32 v104 offset:36768
    ds_write_addtid_b32 v120 offset:38880
    ds_write_addtid_b32 v104 offset:40996
    ds_write_addtid_b32 v120 offset:43108
    ds_write_addtid_b32 v105 offset:37024
    ds_write_addtid_b32 v121 offset:39136
    ds_write_addtid_b32 v105 offset:41252
    ds_write_addtid_b32 v121 offset:43364
    ds_write_addtid_b32 v106 offset:37280
    ds_write_addtid_b32 v122 offset:39392
    ds_write_addtid_b32 v106 offset:41508
    ds_write_addtid_b32 v122 offset:43620
    ds_write_addtid_b32 v107 offset:37536
    ds_write_addtid_b32 v123 offset:39648
    ds_write_addtid_b32 v107 offset:41764
    ds_write_addtid_b32 v123 offset:43876
    ds_write_addtid_b32 v108 offset:37792
    ds_write_addtid_b32 v124 offset:39904
    ds_write_addtid_b32 v108 offset:42020
    ds_write_addtid_b32 v124 offset:44132
    ds_write_addtid_b32 v109 offset:38048
    ds_write_addtid_b32 v125 offset:40160
    ds_write_addtid_b32 v109 offset:42276
    ds_write_addtid_b32 v125 offset:44388
    ds_write_addtid_b32 v110 offset:38304
    ds_write_addtid_b32 v126 offset:40416
    ds_write_addtid_b32 v110 offset:42532
    ds_write_addtid_b32 v126 offset:44644
    ds_write_addtid_b32 v111 offset:38560
    ds_write_addtid_b32 v127 offset:40672
    ds_write_addtid_b32 v111 offset:42788
    ds_write_addtid_b32 v127 offset:44900
    v_mov_b32 v28, 0
    v_mov_b32 v29, 0
    v_mov_b32 v30, 0
    s_cmp_eq_u32 s42, 0
    s_mov_b32 s47, 0x000f000f
    s_cselect_b32 s47, 0x000f0000, s47
    s_mov_b32 exec_lo, s47
    s_mov_b32 exec_hi, 0x000f000f
    global_load_dword v28, v16, s[6:7] offset:-3840
    global_load_dword v29, v16, s[6:7] offset:-2560
    global_load_dword v30, v16, s[6:7] offset:-1280
    s_mov_b64 exec, -1
    global_load_dword v21, v16, s[6:7] offset:1280
    global_load_dword v22, v16, s[6:7] offset:2560
    global_load_dword v23, v16, s[6:7] offset:3840
    global_load_dword v20, v16, s[6:7] offset:0
    global_load_dword v25, v16, s[8:9] offset:0
    global_load_dword v27, v16, s[8:9] offset:1280
    global_load_dword v24, v16, s[8:9] offset:2560
    global_load_dword v26, v16, s[8:9] offset:3840
    s_waitcnt vmcnt(18)
    v_lshlrev_b32 v58, 16, v76
    v_lshlrev_b32 v59, 16, v78
    v_and_b32 v60, 0xffff0000, v76
    v_and_b32 v61, 0xffff0000, v78
    v_lshlrev_b32 v62, 16, v77
    v_lshlrev_b32 v63, 16, v79
    v_and_b32 v64, 0xffff0000, v77
    v_and_b32 v65, 0xffff0000, v79
    s_waitcnt vmcnt(16)
    v_lshlrev_b32 v12, 16, v96
    v_and_b32 v13, 0xffff0000, v96
    v_add_f32 v12, v12, v75
    s_mov_b64 exec, 1
    v_cvt_pk_bf16_f32 v96, v12, v13
    s_mov_b64 exec, -1
    v_mov_b32 v9, 0
    v_mov_b32 v112, 0
    v_mov_b32_dpp v113, v96 wave_ror:1 row_mask:0xf bank_mask:0xf
    s_waitcnt vmcnt(15)
    v_mov_b32_dpp v114, v97 wave_ror:1 row_mask:0xf bank_mask:0xf
    s_waitcnt vmcnt(14)
    v_mov_b32_dpp v115, v98 wave_ror:1 row_mask:0xf bank_mask:0xf
    s_waitcnt vmcnt(13)
    v_mov_b32_dpp v116, v99 wave_ror:1 row_mask:0xf bank_mask:0xf
    s_waitcnt vmcnt(12)
    v_mov_b32_dpp v117, v100 wave_ror:1 row_mask:0xf bank_mask:0xf
    s_waitcnt vmcnt(11)
    v_mov_b32_dpp v118, v101 wave_ror:1 row_mask:0xf bank_mask:0xf
    v_mov_b32_dpp v112, v96 wave_shr:1 row_mask:0xf bank_mask:0xf
    v_mov_b32_dpp v113, v97 wave_shr:1 row_mask:0xf bank_mask:0xf
    v_mov_b32_dpp v114, v98 wave_shr:1 row_mask:0xf bank_mask:0xf
    v_mov_b32_dpp v115, v99 wave_shr:1 row_mask:0xf bank_mask:0xf
    v_mov_b32_dpp v116, v100 wave_shr:1 row_mask:0xf bank_mask:0xf
    v_mov_b32_dpp v117, v101 wave_shr:1 row_mask:0xf bank_mask:0xf
    v_mov_b32_dpp v118, v102 wave_shr:1 row_mask:0xf bank_mask:0xf
    v_alignbit_b32 v112, v96, v112, 16
    v_alignbit_b32 v113, v97, v113, 16
    v_alignbit_b32 v114, v98, v114, 16
    v_alignbit_b32 v115, v99, v115, 16
    v_alignbit_b32 v116, v100, v116, 16
    v_alignbit_b32 v117, v101, v117, 16
    v_alignbit_b32 v118, v102, v118, 16
    ds_read_b64 v[128:129], v2 offset:0
    ds_read_b64 v[130:131], v2 offset:8
    ds_read_b64 v[160:161], v2 offset:512
    ds_read_b64 v[162:163], v2 offset:520
    ds_read_b64 v[192:193], v2 offset:1024
    ds_read_b64 v[194:195], v2 offset:1032
    ds_read_b64 v[224:225], v2 offset:1536
    ds_read_b64 v[226:227], v2 offset:1544
    ds_read_b64 v[132:133], v2 offset:64
    ds_read_b64 v[134:135], v2 offset:72
    ds_read_b64 v[164:165], v2 offset:576
    ds_read_b64 v[166:167], v2 offset:584
    ds_read_b64 v[196:197], v2 offset:1088
    ds_read_b64 v[198:199], v2 offset:1096
    ds_read_b64 v[228:229], v2 offset:1600
    ds_read_b64 v[230:231], v2 offset:1608
    ds_read_b64 v[136:137], v2 offset:128
    ds_read_b64 v[138:139], v2 offset:136
    ds_read_b64 v[168:169], v2 offset:640
    ds_read_b64 v[170:171], v2 offset:648
    ds_read_b64 v[200:201], v2 offset:1152
    ds_read_b64 v[202:203], v2 offset:1160
    ds_read_b64 v[232:233], v2 offset:1664
    ds_read_b64 v[234:235], v2 offset:1672
    ds_read_b64 v[140:141], v2 offset:192
    ds_read_b64 v[142:143], v2 offset:200
    ds_read_b64 v[172:173], v2 offset:704
    ds_read_b64 v[174:175], v2 offset:712
    ds_read_b64 v[204:205], v2 offset:1216
    ds_read_b64 v[206:207], v2 offset:1224
    ds_read_b64 v[236:237], v2 offset:1728
    ds_read_b64 v[238:239], v2 offset:1736
    ds_read_b64 v[144:145], v2 offset:256
    ds_read_b64 v[146:147], v2 offset:264
    ds_read_b64 v[176:177], v2 offset:768
    ds_read_b64 v[178:179], v2 offset:776
    ds_read_b64 v[208:209], v2 offset:1280
    ds_read_b64 v[210:211], v2 offset:1288
    ds_read_b64 v[240:241], v2 offset:1792
    ds_read_b64 v[242:243], v2 offset:1800
    s_waitcnt vmcnt(7)
    v_mov_b32_dpp v28, v21 row_shr:4 row_mask:0xf bank_mask:0xe
    s_waitcnt vmcnt(6)
    v_mov_b32_dpp v29, v22 row_shr:4 row_mask:0xf bank_mask:0xe
    s_waitcnt vmcnt(5)
    v_mov_b32_dpp v30, v23 row_shr:4 row_mask:0xf bank_mask:0xe
    v_lshlrev_b32 v46, 16, v28
    v_and_b32 v47, 0xffff0000, v28
    v_lshlrev_b32 v48, 16, v29
    v_and_b32 v49, 0xffff0000, v29
    v_lshlrev_b32 v50, 16, v30
    v_and_b32 v51, 0xffff0000, v30
    s_waitcnt vmcnt(4)
    v_lshlrev_b32 v44, 16, v20
    v_and_b32 v45, 0xffff0000, v20
    s_waitcnt vmcnt(3)
    v_lshlrev_b32 v52, 16, v25
    v_and_b32 v53, 0xffff0000, v25
    v_pk_mul_f32 v[54:55], v[46:47], v[64:65]
    v_pk_fma_f32 v[54:55], v[48:49], v[62:63], v[54:55]
    v_pk_fma_f32 v[54:55], v[50:51], v[60:61], v[54:55]
    v_pk_fma_f32 v[54:55], v[44:45], v[58:59], v[54:55]
    v_pk_mul_f32 v[54:55], v[54:55], v[52:53]
    v_lshlrev_b32 v46, 16, v21
    v_and_b32 v47, 0xffff0000, v21
    s_waitcnt vmcnt(2)
    v_lshlrev_b32 v52, 16, v27
    v_and_b32 v53, 0xffff0000, v27
    v_pk_mul_f32 v[56:57], v[48:49], v[64:65]
    v_pk_fma_f32 v[56:57], v[50:51], v[62:63], v[56:57]
    v_pk_fma_f32 v[56:57], v[44:45], v[60:61], v[56:57]
    v_pk_fma_f32 v[56:57], v[46:47], v[58:59], v[56:57]
    v_pk_mul_f32 v[56:57], v[56:57], v[52:53]
    v_cvt_pk_bf16_f32 v25, v56, v54
    v_cvt_pk_bf16_f32 v27, v57, v55
    v_lshlrev_b32 v48, 16, v22
    v_and_b32 v49, 0xffff0000, v22
    s_waitcnt vmcnt(1)
    v_lshlrev_b32 v52, 16, v24
    v_and_b32 v53, 0xffff0000, v24
    v_pk_mul_f32 v[54:55], v[50:51], v[64:65]
    v_pk_fma_f32 v[54:55], v[44:45], v[62:63], v[54:55]
    v_pk_fma_f32 v[54:55], v[46:47], v[60:61], v[54:55]
    v_pk_fma_f32 v[54:55], v[48:49], v[58:59], v[54:55]
    v_pk_mul_f32 v[54:55], v[54:55], v[52:53]
    v_lshlrev_b32 v50, 16, v23
    v_and_b32 v51, 0xffff0000, v23
    s_waitcnt vmcnt(0)
    v_lshlrev_b32 v52, 16, v26
    v_and_b32 v53, 0xffff0000, v26
    v_pk_mul_f32 v[56:57], v[44:45], v[64:65]
    v_pk_fma_f32 v[56:57], v[46:47], v[62:63], v[56:57]
    v_pk_fma_f32 v[56:57], v[48:49], v[60:61], v[56:57]
    v_pk_fma_f32 v[56:57], v[50:51], v[58:59], v[56:57]
    v_pk_mul_f32 v[56:57], v[56:57], v[52:53]
    v_cvt_pk_bf16_f32 v24, v56, v54
    v_cvt_pk_bf16_f32 v26, v57, v55
    ds_write_b64 v18, v[24:25] offset:3072
    ds_write_b64 v18, v[26:27] offset:7664
    v_mov_b32 v43, 1
    ds_write_b32 v0, v43 offset:0
    ds_read_b64 v[148:149], v2 offset:320
    ds_read_b64 v[150:151], v2 offset:328
    ds_read_b64 v[180:181], v2 offset:832
    ds_read_b64 v[182:183], v2 offset:840
    ds_read_b64 v[212:213], v2 offset:1344
    ds_read_b64 v[214:215], v2 offset:1352
    ds_read_b64 v[244:245], v2 offset:1856
    ds_read_b64 v[246:247], v2 offset:1864
    ds_read_b64 v[152:153], v2 offset:384
    ds_read_b64 v[154:155], v2 offset:392
    ds_read_b64 v[184:185], v2 offset:896
    ds_read_b64 v[186:187], v2 offset:904
    ds_read_b64 v[216:217], v2 offset:1408
    ds_read_b64 v[218:219], v2 offset:1416
    ds_read_b64 v[248:249], v2 offset:1920
    ds_read_b64 v[250:251], v2 offset:1928
    ds_read_b64 v[156:157], v2 offset:448
    ds_read_b64 v[158:159], v2 offset:456
    ds_read_b64 v[188:189], v2 offset:960
    ds_read_b64 v[190:191], v2 offset:968
    ds_read_b64 v[220:221], v2 offset:1472
    ds_read_b64 v[222:223], v2 offset:1480
    ds_read_b64 v[252:253], v2 offset:1984
    ds_read_b64 v[254:255], v2 offset:1992
    v_add_u32 v16, 655360, v16
    s_mov_b32 exec_lo, 0x000f000f
    s_mov_b32 exec_hi, 0x000f000f
    global_load_dword v40, v16, s[6:7] offset:-3840
    global_load_dword v41, v16, s[6:7] offset:-2560
    global_load_dword v42, v16, s[6:7] offset:-1280
    s_mov_b64 exec, -1
    global_load_dword v33, v16, s[6:7] offset:1280
    global_load_dword v34, v16, s[6:7] offset:2560
    global_load_dword v35, v16, s[6:7] offset:3840
    global_load_dword v32, v16, s[6:7] offset:0
    global_load_dword v37, v16, s[8:9] offset:0
    global_load_dword v39, v16, s[8:9] offset:1280
    global_load_dword v36, v16, s[8:9] offset:2560
    global_load_dword v38, v16, s[8:9] offset:3840
    ds_read_b32 v43, v19 offset:0
    s_mov_b32 exec_lo, 0
    s_mov_b32 exec_hi, 0xff000000
    ds_write_addtid_b32 v9 offset:36512
    ds_write_addtid_b32 v9 offset:38624
    ds_write_addtid_b32 v9 offset:40740
    ds_write_addtid_b32 v9 offset:42852
    s_mov_b64 exec, -1
    ds_write_addtid_b32 v96 offset:36768
    ds_write_addtid_b32 v112 offset:38880
    ds_write_addtid_b32 v96 offset:40996
    ds_write_addtid_b32 v112 offset:43108
    ds_write_addtid_b32 v97 offset:37024
    ds_write_addtid_b32 v113 offset:39136
    ds_write_addtid_b32 v97 offset:41252
    ds_write_addtid_b32 v113 offset:43364
    ds_write_addtid_b32 v98 offset:37280
    ds_write_addtid_b32 v114 offset:39392
    ds_write_addtid_b32 v98 offset:41508
    ds_write_addtid_b32 v114 offset:43620
    ds_write_addtid_b32 v99 offset:37536
    ds_write_addtid_b32 v115 offset:39648
    ds_write_addtid_b32 v99 offset:41764
    ds_write_addtid_b32 v115 offset:43876
    ds_write_addtid_b32 v100 offset:37792
    ds_write_addtid_b32 v116 offset:39904
    ds_write_addtid_b32 v100 offset:42020
    ds_write_addtid_b32 v116 offset:44132
    ds_write_addtid_b32 v101 offset:38048
    ds_write_addtid_b32 v117 offset:40160
    ds_write_addtid_b32 v101 offset:42276
    ds_write_addtid_b32 v117 offset:44388
    ds_write_addtid_b32 v102 offset:38304
    ds_write_addtid_b32 v118 offset:40416
    ds_write_addtid_b32 v102 offset:42532
    ds_write_addtid_b32 v118 offset:44644
    ds_write_addtid_b32 v103 offset:38560
    ds_write_addtid_b32 v119 offset:40672
    ds_write_addtid_b32 v103 offset:42788
    ds_write_addtid_b32 v119 offset:44900
    s_waitcnt lgkmcnt(15)
    v_cmp_gt_u32 vcc, 1, v43
    s_nop 0
    s_and_b32 s46, vcc_lo, 255
    s_cbranch_scc0 Lp_5
Lp_4:
    s_sleep 1
    ds_read_b32 v43, v19 offset:0
    s_waitcnt lgkmcnt(0)
    v_cmp_gt_u32 vcc, 1, v43
    s_nop 0
    s_and_b32 s46, vcc_lo, 255
    s_cbranch_scc1 Lp_4
Lp_5:
    ds_read_b128 v[80:83], v3 offset:3584
    ds_read_b128 v[84:87], v3 offset:3648
    ds_read_b128 v[88:91], v3 offset:3712
    s_setprio 3
    s_waitcnt lgkmcnt(2)
    v_mfma_f32_16x16x32_bf16 v[124:127], v[224:227], v[80:83], 0
    ds_read_b128 v[92:95], v3 offset:3776
    v_mfma_f32_16x16x32_bf16 v[112:115], v[128:131], v[80:83], 0
    ds_read_b64 v[224:225], v2 offset:1536
    v_mfma_f32_16x16x32_bf16 v[116:119], v[160:163], v[80:83], 0
    ds_read_b64 v[226:227], v2 offset:1544
    v_mfma_f32_16x16x32_bf16 v[120:123], v[192:195], v[80:83], 0
    s_waitcnt vmcnt(7)
    v_mov_b32_dpp v40, v33 row_shr:4 row_mask:0xf bank_mask:0xe
    s_waitcnt vmcnt(6)
    v_mov_b32_dpp v41, v34 row_shr:4 row_mask:0xf bank_mask:0xe
    s_waitcnt lgkmcnt(4)
    v_mfma_f32_16x16x32_bf16 v[124:127], v[228:231], v[84:87], v[124:127]
    ds_read_b128 v[80:83], v3 offset:3840
    s_waitcnt vmcnt(5)
    v_mov_b32_dpp v42, v35 row_shr:4 row_mask:0xf bank_mask:0xe
    v_lshlrev_b32 v46, 16, v40
    v_mfma_f32_16x16x32_bf16 v[112:115], v[132:135], v[84:87], v[112:115]
    ds_read_b64 v[228:229], v2 offset:1600
    v_and_b32 v47, 0xffff0000, v40
    v_lshlrev_b32 v48, 16, v41
    v_mfma_f32_16x16x32_bf16 v[116:119], v[164:167], v[84:87], v[116:119]
    ds_read_b64 v[230:231], v2 offset:1608
    v_and_b32 v49, 0xffff0000, v41
    v_lshlrev_b32 v50, 16, v42
    v_mfma_f32_16x16x32_bf16 v[120:123], v[196:199], v[84:87], v[120:123]
    v_and_b32 v51, 0xffff0000, v42
    s_waitcnt vmcnt(4)
    v_lshlrev_b32 v44, 16, v32
    s_waitcnt lgkmcnt(6)
    v_mfma_f32_16x16x32_bf16 v[124:127], v[232:235], v[88:91], v[124:127]
    ds_read_b128 v[84:87], v3 offset:3904
    v_and_b32 v45, 0xffff0000, v32
    s_waitcnt vmcnt(3)
    v_lshlrev_b32 v52, 16, v37
    v_mfma_f32_16x16x32_bf16 v[112:115], v[136:139], v[88:91], v[112:115]
    ds_read_b64 v[232:233], v2 offset:1664
    v_and_b32 v53, 0xffff0000, v37
    v_mul_f32 v54, v46, v64
    v_mfma_f32_16x16x32_bf16 v[116:119], v[168:171], v[88:91], v[116:119]
    ds_read_b64 v[234:235], v2 offset:1672
    v_mul_f32 v55, v47, v65
    v_fmac_f32 v54, v48, v62
    v_mfma_f32_16x16x32_bf16 v[120:123], v[200:203], v[88:91], v[120:123]
    v_fmac_f32 v55, v49, v63
    v_fmac_f32 v54, v50, v60
    s_waitcnt lgkmcnt(8)
    v_mfma_f32_16x16x32_bf16 v[124:127], v[236:239], v[92:95], v[124:127]
    ds_read_b128 v[88:91], v3 offset:3968
    v_fmac_f32 v55, v51, v61
    v_fmac_f32 v54, v44, v58
    v_mfma_f32_16x16x32_bf16 v[112:115], v[140:143], v[92:95], v[112:115]
    ds_read_b64 v[236:237], v2 offset:1728
    v_fmac_f32 v55, v45, v59
    v_mul_f32 v54, v54, v52
    v_mfma_f32_16x16x32_bf16 v[116:119], v[172:175], v[92:95], v[116:119]
    ds_read_b64 v[238:239], v2 offset:1736
    v_mul_f32 v55, v55, v53
    v_lshlrev_b32 v46, 16, v33
    v_mfma_f32_16x16x32_bf16 v[120:123], v[204:207], v[92:95], v[120:123]
    v_and_b32 v47, 0xffff0000, v33
    s_waitcnt vmcnt(2)
    v_lshlrev_b32 v52, 16, v39
    s_waitcnt lgkmcnt(8)
    v_mfma_f32_16x16x32_bf16 v[124:127], v[240:243], v[80:83], v[124:127]
    ds_read_b128 v[92:95], v3 offset:4032
    v_and_b32 v53, 0xffff0000, v39
    v_mul_f32 v56, v48, v64
    v_mfma_f32_16x16x32_bf16 v[112:115], v[144:147], v[80:83], v[112:115]
    ds_read_b64 v[240:241], v2 offset:1792
    v_mul_f32 v57, v49, v65
    v_fmac_f32 v56, v50, v62
    v_mfma_f32_16x16x32_bf16 v[116:119], v[176:179], v[80:83], v[116:119]
    ds_read_b64 v[242:243], v2 offset:1800
    v_fmac_f32 v57, v51, v63
    v_fmac_f32 v56, v44, v60
    v_mfma_f32_16x16x32_bf16 v[120:123], v[208:211], v[80:83], v[120:123]
    v_fmac_f32 v57, v45, v61
    v_fmac_f32 v56, v46, v58
    s_setprio 2
    s_waitcnt lgkmcnt(8)
    v_mfma_f32_16x16x32_bf16 v[124:127], v[244:247], v[84:87], v[124:127]
    ds_read_b128 v[80:83], v3 offset:3072
    v_fmac_f32 v57, v47, v59
    v_mul_f32 v56, v56, v52
    v_mfma_f32_16x16x32_bf16 v[112:115], v[148:151], v[84:87], v[112:115]
    ds_read_b64 v[244:245], v2 offset:1856
    v_mul_f32 v57, v57, v53
    v_cvt_pk_bf16_f32 v37, v56, v54
    v_mfma_f32_16x16x32_bf16 v[116:119], v[180:183], v[84:87], v[116:119]
    ds_read_b64 v[246:247], v2 offset:1864
    v_cvt_pk_bf16_f32 v39, v57, v55
    v_lshlrev_b32 v48, 16, v34
    v_mfma_f32_16x16x32_bf16 v[120:123], v[212:215], v[84:87], v[120:123]
    v_and_b32 v49, 0xffff0000, v34
    s_waitcnt vmcnt(1)
    v_lshlrev_b32 v52, 16, v36
    s_waitcnt lgkmcnt(8)
    v_mfma_f32_16x16x32_bf16 v[124:127], v[248:251], v[88:91], v[124:127]
    ds_read_b128 v[84:87], v3 offset:3136
    v_and_b32 v53, 0xffff0000, v36
    v_mul_f32 v54, v50, v64
    v_mfma_f32_16x16x32_bf16 v[112:115], v[152:155], v[88:91], v[112:115]
    ds_read_b64 v[248:249], v2 offset:1920
    v_mul_f32 v55, v51, v65
    v_fmac_f32 v54, v44, v62
    v_mfma_f32_16x16x32_bf16 v[116:119], v[184:187], v[88:91], v[116:119]
    ds_read_b64 v[250:251], v2 offset:1928
    v_fmac_f32 v55, v45, v63
    v_fmac_f32 v54, v46, v60
    v_mfma_f32_16x16x32_bf16 v[120:123], v[216:219], v[88:91], v[120:123]
    v_fmac_f32 v55, v47, v61
    v_fmac_f32 v54, v48, v58
    s_waitcnt lgkmcnt(8)
    v_mfma_f32_16x16x32_bf16 v[124:127], v[252:255], v[92:95], v[124:127]
    ds_read_b128 v[88:91], v3 offset:3200
    v_fmac_f32 v55, v49, v59
    v_mul_f32 v54, v54, v52
    v_mfma_f32_16x16x32_bf16 v[112:115], v[156:159], v[92:95], v[112:115]
    ds_read_b64 v[252:253], v2 offset:1984
    v_add_u32 v16, 655360, v16
    s_mov_b32 exec_lo, 0x000f000f
    s_mov_b32 exec_hi, 0x000f000f
    global_load_dword v28, v16, s[6:7] offset:-3840
    global_load_dword v29, v16, s[6:7] offset:-2560
    global_load_dword v30, v16, s[6:7] offset:-1280
    s_mov_b64 exec, -1
    v_mul_f32 v55, v55, v53
    v_mfma_f32_16x16x32_bf16 v[116:119], v[188:191], v[92:95], v[116:119]
    ds_read_b64 v[254:255], v2 offset:1992
    v_lshlrev_b32 v50, 16, v35
    v_and_b32 v51, 0xffff0000, v35
    v_mfma_f32_16x16x32_bf16 v[120:123], v[220:223], v[92:95], v[120:123]
    s_waitcnt vmcnt(3)
    v_lshlrev_b32 v52, 16, v38
    v_and_b32 v53, 0xffff0000, v38
    s_waitcnt lgkmcnt(8)
    v_mfma_f32_16x16x32_bf16 v[124:127], v[192:195], v[80:83], v[124:127]
    ds_read_b128 v[92:95], v3 offset:3264
    v_mul_f32 v56, v44, v64
    v_mul_f32 v57, v45, v65
    v_mfma_f32_16x16x32_bf16 v[116:119], v[128:131], v[80:83], v[116:119]
    ds_read_b64 v[192:193], v2 offset:1024
    v_fmac_f32 v56, v46, v62
    v_fmac_f32 v57, v47, v63
    v_mfma_f32_16x16x32_bf16 v[120:123], v[160:163], v[80:83], v[120:123]
    ds_read_b64 v[194:195], v2 offset:1032
    global_load_dword v21, v16, s[6:7] offset:1280
    v_fmac_f32 v56, v48, v60
    v_mfma_f32_16x16x32_bf16 v[112:115], v[224:227], v[80:83], v[112:115]
    v_fmac_f32 v57, v49, v61
    v_fmac_f32 v56, v50, v58
    s_setprio 1
    s_waitcnt lgkmcnt(8)
    v_mfma_f32_16x16x32_bf16 v[124:127], v[196:199], v[84:87], v[124:127]
    ds_read_b128 v[80:83], v3 offset:3328
    v_fmac_f32 v57, v51, v59
    v_mul_f32 v56, v56, v52
    v_mfma_f32_16x16x32_bf16 v[116:119], v[132:135], v[84:87], v[116:119]
    ds_read_b64 v[196:197], v2 offset:1088
    v_mul_f32 v57, v57, v53
    v_cvt_pk_bf16_f32 v36, v56, v54
    v_mfma_f32_16x16x32_bf16 v[120:123], v[164:167], v[84:87], v[120:123]
    ds_read_b64 v[198:199], v2 offset:1096
    v_cvt_pk_bf16_f32 v38, v57, v55
    v_mfma_f32_16x16x32_bf16 v[112:115], v[228:231], v[84:87], v[112:115]
    global_load_dword v22, v16, s[6:7] offset:2560
    s_waitcnt lgkmcnt(8)
    v_mfma_f32_16x16x32_bf16 v[124:127], v[200:203], v[88:91], v[124:127]
    ds_read_b128 v[84:87], v3 offset:3392
    ds_write_b64 v18, v[36:37] offset:2048
    v_mfma_f32_16x16x32_bf16 v[116:119], v[136:139], v[88:91], v[116:119]
    ds_read_b64 v[200:201], v2 offset:1152
    ds_write_b64 v18, v[38:39] offset:6640
    v_mov_b32 v44, 2
    v_mfma_f32_16x16x32_bf16 v[120:123], v[168:171], v[88:91], v[120:123]
    ds_read_b64 v[202:203], v2 offset:1160
    ds_write_b32 v0, v44 offset:0
    v_mfma_f32_16x16x32_bf16 v[112:115], v[232:235], v[88:91], v[112:115]
    s_waitcnt lgkmcnt(11)
    v_mfma_f32_16x16x32_bf16 v[124:127], v[204:207], v[92:95], v[124:127]
    ds_read_b128 v[88:91], v3 offset:3456
    global_load_dword v23, v16, s[6:7] offset:3840
    v_mfma_f32_16x16x32_bf16 v[116:119], v[140:143], v[92:95], v[116:119]
    ds_read_b64 v[204:205], v2 offset:1216
    v_mfma_f32_16x16x32_bf16 v[120:123], v[172:175], v[92:95], v[120:123]
    ds_read_b64 v[206:207], v2 offset:1224
    v_mfma_f32_16x16x32_bf16 v[112:115], v[236:239], v[92:95], v[112:115]
    s_waitcnt lgkmcnt(11)
    v_mfma_f32_16x16x32_bf16 v[124:127], v[208:211], v[80:83], v[124:127]
    ds_read_b128 v[92:95], v3 offset:3520
    v_mfma_f32_16x16x32_bf16 v[116:119], v[144:147], v[80:83], v[116:119]
    ds_read_b64 v[208:209], v2 offset:1280
    global_load_dword v20, v16, s[6:7] offset:0
    v_mfma_f32_16x16x32_bf16 v[120:123], v[176:179], v[80:83], v[120:123]
    ds_read_b64 v[210:211], v2 offset:1288
    v_mfma_f32_16x16x32_bf16 v[112:115], v[240:243], v[80:83], v[112:115]
    s_waitcnt lgkmcnt(11)
    v_mfma_f32_16x16x32_bf16 v[124:127], v[212:215], v[84:87], v[124:127]
    ds_read_b128 v[80:83], v3 offset:3584
    v_mfma_f32_16x16x32_bf16 v[116:119], v[148:151], v[84:87], v[116:119]
    ds_read_b64 v[212:213], v2 offset:1344
    v_mfma_f32_16x16x32_bf16 v[120:123], v[180:183], v[84:87], v[120:123]
    ds_read_b64 v[214:215], v2 offset:1352
    global_load_dword v25, v16, s[8:9] offset:0
    v_mfma_f32_16x16x32_bf16 v[112:115], v[244:247], v[84:87], v[112:115]
    s_setprio 0
    s_waitcnt lgkmcnt(8)
    v_mfma_f32_16x16x32_bf16 v[124:127], v[216:219], v[88:91], v[124:127]
    ds_read_b128 v[84:87], v3 offset:3648
    v_mfma_f32_16x16x32_bf16 v[116:119], v[152:155], v[88:91], v[116:119]
    ds_read_b64 v[216:217], v2 offset:1408
    v_mfma_f32_16x16x32_bf16 v[120:123], v[184:187], v[88:91], v[120:123]
    ds_read_b64 v[218:219], v2 offset:1416
    v_mfma_f32_16x16x32_bf16 v[112:115], v[248:251], v[88:91], v[112:115]
    global_load_dword v27, v16, s[8:9] offset:1280
    s_waitcnt lgkmcnt(8)
    v_mfma_f32_16x16x32_bf16 v[124:127], v[220:223], v[92:95], v[124:127]
    ds_read_b128 v[88:91], v3 offset:3712
    v_mfma_f32_16x16x32_bf16 v[116:119], v[156:159], v[92:95], v[116:119]
    ds_read_b64 v[220:221], v2 offset:1472
    v_mfma_f32_16x16x32_bf16 v[120:123], v[188:191], v[92:95], v[120:123]
    ds_read_b64 v[222:223], v2 offset:1480
    v_mfma_f32_16x16x32_bf16 v[112:115], v[252:255], v[92:95], v[112:115]
    s_waitcnt lgkmcnt(8)
    v_mfma_f32_16x16x32_bf16 v[108:111], v[224:227], v[80:83], 0
    ds_read_b128 v[92:95], v3 offset:3776
    global_load_dword v24, v16, s[8:9] offset:2560
    v_mfma_f32_16x16x32_bf16 v[104:107], v[192:195], v[80:83], 0
    s_waitcnt lgkmcnt(6)
    v_mfma_f32_16x16x32_bf16 v[108:111], v[228:231], v[84:87], v[108:111]
    ds_read_b128 v[80:83], v3 offset:3840
    v_mfma_f32_16x16x32_bf16 v[104:107], v[196:199], v[84:87], v[104:107]
    s_waitcnt lgkmcnt(4)
    v_mfma_f32_16x16x32_bf16 v[108:111], v[232:235], v[88:91], v[108:111]
    ds_read_b128 v[84:87], v3 offset:3904
    v_mfma_f32_16x16x32_bf16 v[104:107], v[200:203], v[88:91], v[104:107]
    ds_read_b32 v43, v19 offset:0
    global_load_dword v26, v16, s[8:9] offset:3840
    s_waitcnt lgkmcnt(3)
    v_mfma_f32_16x16x32_bf16 v[108:111], v[236:239], v[92:95], v[108:111]
    ds_read_b128 v[88:91], v3 offset:3968
    v_mfma_f32_16x16x32_bf16 v[104:107], v[204:207], v[92:95], v[104:107]
    s_waitcnt lgkmcnt(1)
    v_cmp_gt_u32 vcc, 2, v43
    s_nop 0
    s_and_b32 s46, vcc_lo, 255
    s_cbranch_scc0 Lp_7
Lp_6:
    s_sleep 1
    ds_read_b32 v43, v19 offset:0
    s_waitcnt lgkmcnt(0)
    v_cmp_gt_u32 vcc, 2, v43
    s_nop 0
    s_and_b32 s46, vcc_lo, 255
    s_cbranch_scc1 Lp_6
Lp_7:
    s_setprio 3
    v_mfma_f32_16x16x32_bf16 v[108:111], v[240:243], v[80:83], v[108:111]
    ds_read_b128 v[92:95], v3 offset:4032
    v_mfma_f32_16x16x32_bf16 v[104:107], v[208:211], v[80:83], v[104:107]
    v_mfma_f32_16x16x32_bf16 v[108:111], v[244:247], v[84:87], v[108:111]
    ds_read_b128 v[80:83], v3 offset:2560
    v_mfma_f32_16x16x32_bf16 v[104:107], v[212:215], v[84:87], v[104:107]
    s_waitcnt lgkmcnt(2)
    v_mfma_f32_16x16x32_bf16 v[108:111], v[248:251], v[88:91], v[108:111]
    ds_read_b128 v[84:87], v3 offset:2624
    v_mfma_f32_16x16x32_bf16 v[104:107], v[216:219], v[88:91], v[104:107]
    s_waitcnt lgkmcnt(2)
    v_mfma_f32_16x16x32_bf16 v[108:111], v[252:255], v[92:95], v[108:111]
    ds_read_b128 v[88:91], v3 offset:2688
    v_mfma_f32_16x16x32_bf16 v[104:107], v[220:223], v[92:95], v[104:107]
    v_add_u32 v16, 655360, v16
    s_mov_b32 exec_lo, 0x000f000f
    s_mov_b32 exec_hi, 0x000f000f
    global_load_dword v40, v16, s[6:7] offset:-3840
    global_load_dword v41, v16, s[6:7] offset:-2560
    global_load_dword v42, v16, s[6:7] offset:-1280
    s_mov_b64 exec, -1
    s_waitcnt lgkmcnt(2)
    v_mfma_f32_16x16x32_bf16 v[124:127], v[160:163], v[80:83], v[124:127]
    ds_read_b128 v[92:95], v3 offset:2752
    v_mfma_f32_16x16x32_bf16 v[120:123], v[128:131], v[80:83], v[120:123]
    ds_read_b64 v[160:161], v2 offset:512
    v_mfma_f32_16x16x32_bf16 v[116:119], v[224:227], v[80:83], v[116:119]
    ds_read_b64 v[162:163], v2 offset:520
    v_mfma_f32_16x16x32_bf16 v[112:115], v[192:195], v[80:83], v[112:115]
    s_waitcnt lgkmcnt(4)
    v_mfma_f32_16x16x32_bf16 v[124:127], v[164:167], v[84:87], v[124:127]
    ds_read_b128 v[80:83], v3 offset:2816
    global_load_dword v33, v16, s[6:7] offset:1280
    v_mfma_f32_16x16x32_bf16 v[120:123], v[132:135], v[84:87], v[120:123]
    ds_read_b64 v[164:165], v2 offset:576
    v_mfma_f32_16x16x32_bf16 v[116:119], v[228:231], v[84:87], v[116:119]
    ds_read_b64 v[166:167], v2 offset:584
    v_mfma_f32_16x16x32_bf16 v[112:115], v[196:199], v[84:87], v[112:115]
    s_waitcnt lgkmcnt(6)
    v_mfma_f32_16x16x32_bf16 v[124:127], v[168:171], v[88:91], v[124:127]
    ds_read_b128 v[84:87], v3 offset:2880
    v_mfma_f32_16x16x32_bf16 v[120:123], v[136:139], v[88:91], v[120:123]
    ds_read_b64 v[168:169], v2 offset:640
    global_load_dword v34, v16, s[6:7] offset:2560
    v_mfma_f32_16x16x32_bf16 v[116:119], v[232:235], v[88:91], v[116:119]
    ds_read_b64 v[170:171], v2 offset:648
    v_mfma_f32_16x16x32_bf16 v[112:115], v[200:203], v[88:91], v[112:115]
    s_waitcnt lgkmcnt(8)
    v_mfma_f32_16x16x32_bf16 v[124:127], v[172:175], v[92:95], v[124:127]
    ds_read_b128 v[88:91], v3 offset:2944
    v_mfma_f32_16x16x32_bf16 v[120:123], v[140:143], v[92:95], v[120:123]
    ds_read_b64 v[172:173], v2 offset:704
    v_mfma_f32_16x16x32_bf16 v[116:119], v[236:239], v[92:95], v[116:119]
    ds_read_b64 v[174:175], v2 offset:712
    global_load_dword v35, v16, s[6:7] offset:3840
    v_mfma_f32_16x16x32_bf16 v[112:115], v[204:207], v[92:95], v[112:115]
    s_waitcnt lgkmcnt(8)
    v_mfma_f32_16x16x32_bf16 v[124:127], v[176:179], v[80:83], v[124:127]
    ds_read_b128 v[92:95], v3 offset:3008
    v_mfma_f32_16x16x32_bf16 v[120:123], v[144:147], v[80:83], v[120:123]
    ds_read_b64 v[176:177], v2 offset:768
    v_mfma_f32_16x16x32_bf16 v[116:119], v[240:243], v[80:83], v[116:119]
    ds_read_b64 v[178:179], v2 offset:776
    v_mfma_f32_16x16x32_bf16 v[112:115], v[208:211], v[80:83], v[112:115]
    global_load_dword v32, v16, s[6:7] offset:0
    s_waitcnt vmcnt(14)
    v_mov_b32_dpp v28, v21 row_shr:4 row_mask:0xf bank_mask:0xe
    s_waitcnt lgkmcnt(8)
    v_mfma_f32_16x16x32_bf16 v[124:127], v[180:183], v[84:87], v[124:127]
    ds_read_b128 v[80:83], v3 offset:2048
    s_waitcnt vmcnt(13)
    v_mov_b32_dpp v29, v22 row_shr:4 row_mask:0xf bank_mask:0xe
    s_waitcnt vmcnt(12)
    v_mov_b32_dpp v30, v23 row_shr:4 row_mask:0xf bank_mask:0xe
    v_mfma_f32_16x16x32_bf16 v[120:123], v[148:151], v[84:87], v[120:123]
    ds_read_b64 v[180:181], v2 offset:832
    v_lshlrev_b32 v46, 16, v28
    v_and_b32 v47, 0xffff0000, v28
    v_mfma_f32_16x16x32_bf16 v[116:119], v[244:247], v[84:87], v[116:119]
    ds_read_b64 v[182:183], v2 offset:840
    v_lshlrev_b32 v48, 16, v29
    v_and_b32 v49, 0xffff0000, v29
    v_mfma_f32_16x16x32_bf16 v[112:115], v[212:215], v[84:87], v[112:115]
    v_lshlrev_b32 v50, 16, v30
    v_and_b32 v51, 0xffff0000, v30
    s_setprio 2
    s_waitcnt lgkmcnt(8)
    v_mfma_f32_16x16x32_bf16 v[124:127], v[184:187], v[88:91], v[124:127]
    ds_read_b128 v[84:87], v3 offset:2112
    global_load_dword v37, v16, s[8:9] offset:0
    s_waitcnt vmcnt(12)
    v_lshlrev_b32 v44, 16, v20
    v_mfma_f32_16x16x32_bf16 v[120:123], v[152:155], v[88:91], v[120:123]
    ds_read_b64 v[184:185], v2 offset:896
    v_and_b32 v45, 0xffff0000, v20
    s_waitcnt vmcnt(11)
    v_lshlrev_b32 v52, 16, v25
    v_mfma_f32_16x16x32_bf16 v[116:119], v[248:251], v[88:91], v[116:119]
    ds_read_b64 v[186:187], v2 offset:904
    v_and_b32 v53, 0xffff0000, v25
    v_mul_f32 v54, v46, v64
    v_mfma_f32_16x16x32_bf16 v[112:115], v[216:219], v[88:91], v[112:115]
    v_mul_f32 v55, v47, v65
    v_fmac_f32 v54, v48, v62
    s_waitcnt lgkmcnt(8)
    v_mfma_f32_16x16x32_bf16 v[124:127], v[188:191], v[92:95], v[124:127]
    ds_read_b128 v[88:91], v3 offset:2176
    v_fmac_f32 v55, v49, v63
    v_fmac_f32 v54, v50, v60
    v_mfma_f32_16x16x32_bf16 v[120:123], v[156:159], v[92:95], v[120:123]
    ds_read_b64 v[188:189], v2 offset:960
    global_load_dword v39, v16, s[8:9] offset:1280
    v_fmac_f32 v55, v51, v61
    v_mfma_f32_16x16x32_bf16 v[116:119], v[252:255], v[92:95], v[116:119]
    ds_read_b64 v[190:191], v2 offset:968
    v_fmac_f32 v54, v44, v58
    v_fmac_f32 v55, v45, v59
    v_mfma_f32_16x16x32_bf16 v[112:115], v[220:223], v[92:95], v[112:115]
    v_mul_f32 v54, v54, v52
    v_mul_f32 v55, v55, v53
    s_waitcnt lgkmcnt(8)
    v_mfma_f32_16x16x32_bf16 v[124:127], v[128:131], v[80:83], v[124:127]
    ds_read_b128 v[92:95], v3 offset:2240
    v_lshlrev_b32 v46, 16, v21
    v_and_b32 v47, 0xffff0000, v21
    v_mfma_f32_16x16x32_bf16 v[120:123], v[224:227], v[80:83], v[120:123]
    ds_read_b64 v[128:129], v2 offset:0
    s_waitcnt vmcnt(11)
    v_lshlrev_b32 v52, 16, v27
    v_and_b32 v53, 0xffff0000, v27
    v_mfma_f32_16x16x32_bf16 v[116:119], v[192:195], v[80:83], v[116:119]
    ds_read_b64 v[130:131], v2 offset:8
    global_load_dword v36, v16, s[8:9] offset:2560
    v_mul_f32 v56, v48, v64
    v_mfma_f32_16x16x32_bf16 v[112:115], v[160:163], v[80:83], v[112:115]
    v_mul_f32 v57, v49, v65
    v_fmac_f32 v56, v50, v62
    s_waitcnt lgkmcnt(8)
    v_mfma_f32_16x16x32_bf16 v[124:127], v[132:135], v[84:87], v[124:127]
    ds_read_b128 v[80:83], v3 offset:2304
    v_fmac_f32 v57, v51, v63
    v_fmac_f32 v56, v44, v60
    v_mfma_f32_16x16x32_bf16 v[120:123], v[228:231], v[84:87], v[120:123]
    ds_read_b64 v[132:133], v2 offset:64
    v_fmac_f32 v57, v45, v61
    v_fmac_f32 v56, v46, v58
    v_mfma_f32_16x16x32_bf16 v[116:119], v[196:199], v[84:87], v[116:119]
    ds_read_b64 v[134:135], v2 offset:72
    v_fmac_f32 v57, v47, v59
    v_mul_f32 v56, v56, v52
    v_mfma_f32_16x16x32_bf16 v[112:115], v[164:167], v[84:87], v[112:115]
    global_load_dword v38, v16, s[8:9] offset:3840
    v_mul_f32 v57, v57, v53
    s_waitcnt lgkmcnt(8)
    v_mfma_f32_16x16x32_bf16 v[124:127], v[136:139], v[88:91], v[124:127]
    ds_read_b128 v[84:87], v3 offset:2368
    v_cvt_pk_bf16_f32 v25, v56, v54
    v_cvt_pk_bf16_f32 v27, v57, v55
    v_mfma_f32_16x16x32_bf16 v[120:123], v[232:235], v[88:91], v[120:123]
    ds_read_b64 v[136:137], v2 offset:128
    v_lshlrev_b32 v48, 16, v22
    v_and_b32 v49, 0xffff0000, v22
    v_mfma_f32_16x16x32_bf16 v[116:119], v[200:203], v[88:91], v[116:119]
    ds_read_b64 v[138:139], v2 offset:136
    s_waitcnt vmcnt(12)
    v_lshlrev_b32 v52, 16, v24
    v_and_b32 v53, 0xffff0000, v24
    v_mfma_f32_16x16x32_bf16 v[112:115], v[168:171], v[88:91], v[112:115]
    v_mul_f32 v54, v50, v64
    v_mul_f32 v55, v51, v65
    s_waitcnt lgkmcnt(8)
    v_mfma_f32_16x16x32_bf16 v[124:127], v[140:143], v[92:95], v[124:127]
    ds_read_b128 v[88:91], v3 offset:2432
    v_fmac_f32 v54, v44, v62
    v_fmac_f32 v55, v45, v63
    v_mfma_f32_16x16x32_bf16 v[120:123], v[236:239], v[92:95], v[120:123]
    ds_read_b64 v[140:141], v2 offset:192
    v_fmac_f32 v54, v46, v60
    v_fmac_f32 v55, v47, v61
    v_mfma_f32_16x16x32_bf16 v[116:119], v[204:207], v[92:95], v[116:119]
    ds_read_b64 v[142:143], v2 offset:200
    v_fmac_f32 v54, v48, v58
    v_fmac_f32 v55, v49, v59
    v_mfma_f32_16x16x32_bf16 v[112:115], v[172:175], v[92:95], v[112:115]
    v_mul_f32 v54, v54, v52
    v_mul_f32 v55, v55, v53
    s_waitcnt lgkmcnt(8)
    v_mfma_f32_16x16x32_bf16 v[124:127], v[144:147], v[80:83], v[124:127]
    ds_read_b128 v[92:95], v3 offset:2496
    v_lshlrev_b32 v50, 16, v23
    v_and_b32 v51, 0xffff0000, v23
    v_mfma_f32_16x16x32_bf16 v[120:123], v[240:243], v[80:83], v[120:123]
    ds_read_b64 v[144:145], v2 offset:256
    v_add_u32 v4, 0, v7
    global_load_dwordx4 v[12:15], v4, s[4:5]
    s_waitcnt vmcnt(12)
    v_lshlrev_b32 v52, 16, v26
    v_mfma_f32_16x16x32_bf16 v[116:119], v[208:211], v[80:83], v[116:119]
    ds_read_b64 v[146:147], v2 offset:264
    v_and_b32 v53, 0xffff0000, v26
    v_mul_f32 v56, v44, v64
    v_mfma_f32_16x16x32_bf16 v[112:115], v[176:179], v[80:83], v[112:115]
    v_mul_f32 v57, v45, v65
    v_fmac_f32 v56, v46, v62
    s_setprio 1
    s_waitcnt lgkmcnt(8)
    v_mfma_f32_16x16x32_bf16 v[124:127], v[148:151], v[84:87], v[124:127]
    ds_read_b128 v[80:83], v3 offset:3584
    v_fmac_f32 v57, v47, v63
    v_fmac_f32 v56, v48, v60
    v_mfma_f32_16x16x32_bf16 v[120:123], v[244:247], v[84:87], v[120:123]
    ds_read_b64 v[148:149], v2 offset:320
    v_fmac_f32 v57, v49, v61
    v_fmac_f32 v56, v50, v58
    v_mfma_f32_16x16x32_bf16 v[116:119], v[212:215], v[84:87], v[116:119]
    ds_read_b64 v[150:151], v2 offset:328
    v_fmac_f32 v57, v51, v59
    v_mul_f32 v56, v56, v52
    v_mfma_f32_16x16x32_bf16 v[112:115], v[180:183], v[84:87], v[112:115]
    v_mul_f32 v57, v57, v53
    v_cvt_pk_bf16_f32 v24, v56, v54
    s_waitcnt lgkmcnt(8)
    v_mfma_f32_16x16x32_bf16 v[124:127], v[152:155], v[88:91], v[124:127]
    ds_read_b128 v[84:87], v3 offset:3648
    v_cvt_pk_bf16_f32 v26, v57, v55
    v_mfma_f32_16x16x32_bf16 v[120:123], v[248:251], v[88:91], v[120:123]
    ds_read_b64 v[152:153], v2 offset:384
    ds_write_b64 v18, v[24:25] offset:1024
    v_mfma_f32_16x16x32_bf16 v[116:119], v[216:219], v[88:91], v[116:119]
    ds_read_b64 v[154:155], v2 offset:392
    ds_write_b64 v18, v[26:27] offset:5616
    v_mov_b32 v44, 3
    v_mfma_f32_16x16x32_bf16 v[112:115], v[184:187], v[88:91], v[112:115]
    ds_write_b32 v0, v44 offset:0
    s_waitcnt lgkmcnt(11)
    v_mfma_f32_16x16x32_bf16 v[124:127], v[156:159], v[92:95], v[124:127]
    ds_read_b128 v[88:91], v3 offset:3712
    v_mfma_f32_16x16x32_bf16 v[120:123], v[252:255], v[92:95], v[120:123]
    ds_read_b64 v[156:157], v2 offset:448
    v_mfma_f32_16x16x32_bf16 v[116:119], v[220:223], v[92:95], v[116:119]
    ds_read_b64 v[158:159], v2 offset:456
    v_mfma_f32_16x16x32_bf16 v[112:115], v[188:191], v[92:95], v[112:115]
    s_waitcnt lgkmcnt(11)
    v_mfma_f32_16x16x32_bf16 v[100:103], v[160:163], v[80:83], 0
    ds_read_b128 v[92:95], v3 offset:3776
    v_mfma_f32_16x16x32_bf16 v[96:99], v[128:131], v[80:83], 0
    s_waitcnt lgkmcnt(9)
    v_mfma_f32_16x16x32_bf16 v[100:103], v[164:167], v[84:87], v[100:103]
    ds_read_b128 v[80:83], v3 offset:3840
    v_mfma_f32_16x16x32_bf16 v[96:99], v[132:135], v[84:87], v[96:99]
    s_waitcnt lgkmcnt(4)
    v_mfma_f32_16x16x32_bf16 v[100:103], v[168:171], v[88:91], v[100:103]
    ds_read_b128 v[84:87], v3 offset:3904
    v_mfma_f32_16x16x32_bf16 v[96:99], v[136:139], v[88:91], v[96:99]
    s_waitcnt vmcnt(8)
    v_mov_b32_dpp v40, v33 row_shr:4 row_mask:0xf bank_mask:0xe
    s_waitcnt vmcnt(7)
    v_mov_b32_dpp v41, v34 row_shr:4 row_mask:0xf bank_mask:0xe
    s_waitcnt lgkmcnt(2)
    v_mfma_f32_16x16x32_bf16 v[100:103], v[172:175], v[92:95], v[100:103]
    ds_read_b128 v[88:91], v3 offset:3968
    s_waitcnt vmcnt(6)
    v_mov_b32_dpp v42, v35 row_shr:4 row_mask:0xf bank_mask:0xe
    v_lshlrev_b32 v46, 16, v40
    v_mfma_f32_16x16x32_bf16 v[96:99], v[140:143], v[92:95], v[96:99]
    v_and_b32 v47, 0xffff0000, v40
    v_lshlrev_b32 v48, 16, v41
    s_waitcnt lgkmcnt(2)
    v_mfma_f32_16x16x32_bf16 v[100:103], v[176:179], v[80:83], v[100:103]
    ds_read_b128 v[92:95], v3 offset:4032
    v_and_b32 v49, 0xffff0000, v41
    v_lshlrev_b32 v50, 16, v42
    v_mfma_f32_16x16x32_bf16 v[96:99], v[144:147], v[80:83], v[96:99]
    v_and_b32 v51, 0xffff0000, v42
    s_waitcnt vmcnt(5)
    v_lshlrev_b32 v44, 16, v32
    s_waitcnt lgkmcnt(2)
    v_mfma_f32_16x16x32_bf16 v[100:103], v[180:183], v[84:87], v[100:103]
    ds_read_b128 v[80:83], v3 offset:3072
    v_and_b32 v45, 0xffff0000, v32
    s_waitcnt vmcnt(4)
    v_lshlrev_b32 v52, 16, v37
    v_mfma_f32_16x16x32_bf16 v[96:99], v[148:151], v[84:87], v[96:99]
    v_and_b32 v53, 0xffff0000, v37
    v_mul_f32 v54, v46, v64
    s_waitcnt lgkmcnt(2)
    v_mfma_f32_16x16x32_bf16 v[100:103], v[184:187], v[88:91], v[100:103]
    ds_read_b128 v[84:87], v3 offset:3136
    v_mul_f32 v55, v47, v65
    v_fmac_f32 v54, v48, v62
    v_mfma_f32_16x16x32_bf16 v[96:99], v[152:155], v[88:91], v[96:99]
    v_fmac_f32 v55, v49, v63
    v_fmac_f32 v54, v50, v60
    s_waitcnt lgkmcnt(2)
    v_mfma_f32_16x16x32_bf16 v[100:103], v[188:191], v[92:95], v[100:103]
    ds_read_b128 v[88:91], v3 offset:3200
    v_fmac_f32 v55, v51, v61
    v_fmac_f32 v54, v44, v58
    v_mfma_f32_16x16x32_bf16 v[96:99], v[156:159], v[92:95], v[96:99]
    v_fmac_f32 v55, v45, v59
    v_mul_f32 v54, v54, v52
    s_waitcnt lgkmcnt(2)
    v_mfma_f32_16x16x32_bf16 v[100:103], v[128:131], v[80:83], v[100:103]
    ds_read_b128 v[92:95], v3 offset:3264
    v_mul_f32 v55, v55, v53
    v_lshlrev_b32 v46, 16, v33
    v_mfma_f32_16x16x32_bf16 v[104:107], v[160:163], v[80:83], v[104:107]
    v_cvt_pk_bf16_f32 v10, v96, v97
    v_cvt_pk_bf16_f32 v11, v98, v99
    v_mfma_f32_16x16x32_bf16 v[108:111], v[192:195], v[80:83], v[108:111]
    ds_write_b64 v5, v[10:11] offset:0
    v_and_b32 v47, 0xffff0000, v33
    s_setprio 0
    s_waitcnt lgkmcnt(3)
    v_mfma_f32_16x16x32_bf16 v[100:103], v[132:135], v[84:87], v[100:103]
    ds_read_b128 v[80:83], v3 offset:3328
    s_waitcnt vmcnt(3)
    v_lshlrev_b32 v52, 16, v39
    v_and_b32 v53, 0xffff0000, v39
    v_mfma_f32_16x16x32_bf16 v[104:107], v[164:167], v[84:87], v[104:107]
    v_mul_f32 v56, v48, v64
    v_mul_f32 v57, v49, v65
    v_mfma_f32_16x16x32_bf16 v[108:111], v[196:199], v[84:87], v[108:111]
    v_fmac_f32 v56, v50, v62
    v_fmac_f32 v57, v51, v63
    s_waitcnt lgkmcnt(3)
    v_mfma_f32_16x16x32_bf16 v[100:103], v[136:139], v[88:91], v[100:103]
    ds_read_b128 v[84:87], v3 offset:3392
    v_fmac_f32 v56, v44, v60
    v_fmac_f32 v57, v45, v61
    v_mfma_f32_16x16x32_bf16 v[104:107], v[168:171], v[88:91], v[104:107]
    v_fmac_f32 v56, v46, v58
    v_fmac_f32 v57, v47, v59
    v_mfma_f32_16x16x32_bf16 v[108:111], v[200:203], v[88:91], v[108:111]
    v_mul_f32 v56, v56, v52
    v_mul_f32 v57, v57, v53
    s_waitcnt lgkmcnt(3)
    v_mfma_f32_16x16x32_bf16 v[100:103], v[140:143], v[92:95], v[100:103]
    ds_read_b128 v[88:91], v3 offset:3456
    v_add_u32 v4, 655360, v7
    global_load_dwordx4 v[20:23], v4, s[4:5]
    v_cvt_pk_bf16_f32 v37, v56, v54
    v_mfma_f32_16x16x32_bf16 v[104:107], v[172:175], v[92:95], v[104:107]
    v_cvt_pk_bf16_f32 v39, v57, v55
    v_lshlrev_b32 v48, 16, v34
    v_mfma_f32_16x16x32_bf16 v[108:111], v[204:207], v[92:95], v[108:111]
    v_and_b32 v49, 0xffff0000, v34
    s_waitcnt vmcnt(3)
    v_lshlrev_b32 v52, 16, v36
    s_waitcnt lgkmcnt(2)
    v_mfma_f32_16x16x32_bf16 v[100:103], v[144:147], v[80:83], v[100:103]
    ds_read_b128 v[92:95], v3 offset:3520
    v_and_b32 v53, 0xffff0000, v36
    v_mul_f32 v54, v50, v64
    v_mfma_f32_16x16x32_bf16 v[104:107], v[176:179], v[80:83], v[104:107]
    v_mul_f32 v55, v51, v65
    v_fmac_f32 v54, v44, v62
    v_mfma_f32_16x16x32_bf16 v[108:111], v[208:211], v[80:83], v[108:111]
    v_fmac_f32 v55, v45, v63
    v_fmac_f32 v54, v46, v60
    s_waitcnt lgkmcnt(2)
    v_mfma_f32_16x16x32_bf16 v[100:103], v[148:151], v[84:87], v[100:103]
    ds_read_b128 v[80:83], v3 offset:2560
    v_fmac_f32 v55, v47, v61
    v_fmac_f32 v54, v48, v58
    v_mfma_f32_16x16x32_bf16 v[104:107], v[180:183], v[84:87], v[104:107]
    v_fmac_f32 v55, v49, v59
    v_mul_f32 v54, v54, v52
    v_mfma_f32_16x16x32_bf16 v[108:111], v[212:215], v[84:87], v[108:111]
    v_mul_f32 v55, v55, v53
    v_lshlrev_b32 v50, 16, v35
    s_waitcnt lgkmcnt(2)
    v_mfma_f32_16x16x32_bf16 v[100:103], v[152:155], v[88:91], v[100:103]
    ds_read_b128 v[84:87], v3 offset:2624
    v_and_b32 v51, 0xffff0000, v35
    s_waitcnt vmcnt(2)
    v_lshlrev_b32 v52, 16, v38
    v_mfma_f32_16x16x32_bf16 v[104:107], v[184:187], v[88:91], v[104:107]
    v_and_b32 v53, 0xffff0000, v38
    v_mul_f32 v56, v44, v64
    v_mfma_f32_16x16x32_bf16 v[108:111], v[216:219], v[88:91], v[108:111]
    v_mul_f32 v57, v45, v65
    v_fmac_f32 v56, v46, v62
    s_waitcnt lgkmcnt(2)
    v_mfma_f32_16x16x32_bf16 v[100:103], v[156:159], v[92:95], v[100:103]
    ds_read_b128 v[88:91], v3 offset:2688
    v_fmac_f32 v57, v47, v63
    v_fmac_f32 v56, v48, v60
    v_mfma_f32_16x16x32_bf16 v[104:107], v[188:191], v[92:95], v[104:107]
    v_fmac_f32 v57, v49, v61
    v_fmac_f32 v56, v50, v58
    v_mfma_f32_16x16x32_bf16 v[108:111], v[220:223], v[92:95], v[108:111]
    v_fmac_f32 v57, v51, v59
    v_mul_f32 v56, v56, v52
    s_waitcnt lgkmcnt(2)
    v_mfma_f32_16x16x32_bf16 v[104:107], v[128:131], v[80:83], v[104:107]
    ds_read_b128 v[92:95], v3 offset:2752
    v_mul_f32 v57, v57, v53
    v_cvt_pk_bf16_f32 v36, v56, v54
    v_mfma_f32_16x16x32_bf16 v[108:111], v[160:163], v[80:83], v[108:111]
    v_cvt_pk_bf16_f32 v10, v100, v101
    v_cvt_pk_bf16_f32 v11, v102, v103
    s_waitcnt lgkmcnt(2)
    v_mfma_f32_16x16x32_bf16 v[104:107], v[132:135], v[84:87], v[104:107]
    ds_read_b128 v[80:83], v3 offset:2816
    ds_write_b64 v5, v[10:11] offset:4608
    v_mov_b32 v17, 1
    v_mfma_f32_16x16x32_bf16 v[108:111], v[164:167], v[84:87], v[108:111]
    ds_write_b32 v0, v17 offset:2048
    v_cvt_pk_bf16_f32 v38, v57, v55
    s_waitcnt lgkmcnt(4)
    v_mfma_f32_16x16x32_bf16 v[104:107], v[136:139], v[88:91], v[104:107]
    ds_read_b128 v[84:87], v3 offset:2880
    ds_write_b64 v18, v[36:37] offset:0
    v_mfma_f32_16x16x32_bf16 v[108:111], v[168:171], v[88:91], v[108:111]
    ds_read_b32 v66, v19 offset:2048
    ds_write_b64 v18, v[38:39] offset:4592
    v_mov_b32 v44, 4
    s_waitcnt lgkmcnt(7)
    v_mfma_f32_16x16x32_bf16 v[104:107], v[140:143], v[92:95], v[104:107]
    ds_read_b128 v[88:91], v3 offset:2944
    ds_write_b32 v0, v44 offset:0
    v_mfma_f32_16x16x32_bf16 v[108:111], v[172:175], v[92:95], v[108:111]
    s_waitcnt lgkmcnt(3)
    v_cmp_gt_u32 vcc, 1, v66
    s_nop 0
    s_and_b32 s46, vcc_lo, 255
    s_cbranch_scc0 Lp_9
Lp_8:
    s_sleep 1
    ds_read_b32 v66, v19 offset:2048
    s_waitcnt lgkmcnt(0)
    v_cmp_gt_u32 vcc, 1, v66
    s_nop 0
    s_and_b32 s46, vcc_lo, 255
    s_cbranch_scc1 Lp_8
Lp_9:
    s_setprio 3
    v_mfma_f32_16x16x32_bf16 v[104:107], v[144:147], v[80:83], v[104:107]
    ds_read_b128 v[92:95], v3 offset:3008
    v_mfma_f32_16x16x32_bf16 v[108:111], v[176:179], v[80:83], v[108:111]
    ds_read_b64_tr_b16 v[68:69], v6 offset:0
    v_mfma_f32_16x16x32_bf16 v[104:107], v[148:151], v[84:87], v[104:107]
    ds_read_b128 v[80:83], v3 offset:2048
    v_add_u32 v4, 1310720, v7
    global_load_dwordx4 v[24:27], v4, s[4:5]
    v_mfma_f32_16x16x32_bf16 v[108:111], v[180:183], v[84:87], v[108:111]
    ds_read_b64_tr_b16 v[70:71], v6 offset:2304
    v_lshlrev_b32 v9, 1, v7
    v_subrev_u32 v9, s55, v9
    s_setprio 2
    s_waitcnt lgkmcnt(5)
    v_mfma_f32_16x16x32_bf16 v[104:107], v[152:155], v[88:91], v[104:107]
    ds_read_b128 v[84:87], v3 offset:2112
    v_add_u32 v9, 0, v9
    s_waitcnt vmcnt(2)
    v_lshlrev_b32 v74, 16, v12
    v_mfma_f32_16x16x32_bf16 v[108:111], v[184:187], v[88:91], v[108:111]
    v_and_b32 v75, 0xffff0000, v12
    s_setprio 1
    s_waitcnt lgkmcnt(4)
    v_mfma_f32_16x16x32_bf16 v[104:107], v[156:159], v[92:95], v[104:107]
    ds_read_b128 v[88:91], v3 offset:2176
    v_mfma_f32_16x16x32_bf16 v[108:111], v[188:191], v[92:95], v[108:111]
    s_waitcnt lgkmcnt(4)
    v_lshlrev_b32 v72, 16, v68
    v_and_b32 v73, 0xffff0000, v68
    s_waitcnt lgkmcnt(3)
    v_mfma_f32_16x16x32_bf16 v[108:111], v[128:131], v[80:83], v[108:111]
    ds_read_b128 v[92:95], v3 offset:2240
    v_mul_f32 v72, v72, v74
    v_mul_f32 v73, v73, v75
    s_setprio 0
    s_waitcnt lgkmcnt(2)
    v_mfma_f32_16x16x32_bf16 v[108:111], v[132:135], v[84:87], v[108:111]
    ds_read_b128 v[80:83], v3 offset:2304
    v_cvt_pk_bf16_f32 v10, v104, v105
    v_cvt_pk_bf16_f32 v11, v106, v107
    s_waitcnt lgkmcnt(2)
    v_mfma_f32_16x16x32_bf16 v[108:111], v[136:139], v[88:91], v[108:111]
    ds_read_b128 v[84:87], v3 offset:2368
    ds_read_b32 v43, v19 offset:0
    ds_write_b64 v5, v[10:11] offset:9216
    v_cvt_pk_bf16_f32 v76, v72, v73
    s_waitcnt lgkmcnt(4)
    v_mfma_f32_16x16x32_bf16 v[108:111], v[140:143], v[92:95], v[108:111]
    ds_read_b128 v[88:91], v3 offset:2432
    v_lshlrev_b32 v74, 16, v13
    v_and_b32 v75, 0xffff0000, v13
    s_waitcnt lgkmcnt(2)
    v_cmp_gt_u32 vcc, 3, v43
    s_nop 0
    s_and_b32 s46, vcc_lo, 255
    s_cbranch_scc0 Lp_11
Lp_10:
    s_sleep 1
    ds_read_b32 v43, v19 offset:0
    s_waitcnt lgkmcnt(0)
    v_cmp_gt_u32 vcc, 3, v43
    s_nop 0
    s_and_b32 s46, vcc_lo, 255
    s_cbranch_scc1 Lp_10
Lp_11:
    s_setprio 3
    v_mfma_f32_16x16x32_bf16 v[108:111], v[144:147], v[80:83], v[108:111]
    ds_read_b128 v[92:95], v3 offset:2496
    v_lshlrev_b32 v72, 16, v69
    v_and_b32 v73, 0xffff0000, v69
    v_mfma_f32_16x16x32_bf16 v[108:111], v[148:151], v[84:87], v[108:111]
    ds_read_b128 v[80:83], v3 offset:1536
    v_mul_f32 v72, v72, v74
    v_mul_f32 v73, v73, v75
    s_waitcnt lgkmcnt(2)
    v_mfma_f32_16x16x32_bf16 v[108:111], v[152:155], v[88:91], v[108:111]
    ds_read_b128 v[84:87], v3 offset:1600
    v_cvt_pk_bf16_f32 v77, v72, v73
    v_lshlrev_b32 v74, 16, v14
    s_waitcnt lgkmcnt(2)
    v_mfma_f32_16x16x32_bf16 v[108:111], v[156:159], v[92:95], v[108:111]
    ds_read_b128 v[88:91], v3 offset:1664
    v_and_b32 v75, 0xffff0000, v14
    v_lshlrev_b32 v72, 16, v70
    s_setprio 2
    s_waitcnt lgkmcnt(2)
    v_mfma_f32_16x16x32_bf16 v[112:115], v[128:131], v[80:83], v[112:115]
    ds_read_b128 v[92:95], v3 offset:1728
    v_and_b32 v73, 0xffff0000, v70
    v_mul_f32 v72, v72, v74
    v_mfma_f32_16x16x32_bf16 v[116:119], v[160:163], v[80:83], v[116:119]
    v_cvt_pk_bf16_f32 v10, v108, v109
    v_cvt_pk_bf16_f32 v11, v110, v111
    s_waitcnt lgkmcnt(2)
    v_mfma_f32_16x16x32_bf16 v[112:115], v[132:135], v[84:87], v[112:115]
    ds_read_b128 v[80:83], v3 offset:1792
    ds_write_b64 v5, v[10:11] offset:13824
    v_mov_b32 v17, 2
    v_mfma_f32_16x16x32_bf16 v[116:119], v[164:167], v[84:87], v[116:119]
    ds_write_b32 v0, v17 offset:2048
    v_mul_f32 v73, v73, v75
    s_setprio 1
    s_waitcnt lgkmcnt(4)
    v_mfma_f32_16x16x32_bf16 v[112:115], v[136:139], v[88:91], v[112:115]
    ds_read_b128 v[84:87], v3 offset:1856
    v_cvt_pk_bf16_f32 v78, v72, v73
    v_lshlrev_b32 v74, 16, v15
    v_mfma_f32_16x16x32_bf16 v[116:119], v[168:171], v[88:91], v[116:119]
    v_and_b32 v75, 0xffff0000, v15
    v_lshlrev_b32 v72, 16, v71
    s_waitcnt lgkmcnt(4)
    v_mfma_f32_16x16x32_bf16 v[112:115], v[140:143], v[92:95], v[112:115]
    ds_read_b128 v[88:91], v3 offset:1920
    v_and_b32 v73, 0xffff0000, v71
    v_mul_f32 v72, v72, v74
    v_mfma_f32_16x16x32_bf16 v[116:119], v[172:175], v[92:95], v[116:119]
    v_mul_f32 v73, v73, v75
    v_cvt_pk_bf16_f32 v79, v72, v73
    s_setprio 0
    s_waitcnt lgkmcnt(4)
    v_mfma_f32_16x16x32_bf16 v[112:115], v[144:147], v[80:83], v[112:115]
    ds_read_b128 v[92:95], v3 offset:1984
    global_store_dwordx4 v9, v[76:79], s[34:35]
    v_mfma_f32_16x16x32_bf16 v[116:119], v[176:179], v[80:83], v[116:119]
    ds_read_b32 v66, v19 offset:2048
    s_waitcnt lgkmcnt(3)
    v_mfma_f32_16x16x32_bf16 v[112:115], v[148:151], v[84:87], v[112:115]
    ds_read_b128 v[80:83], v3 offset:1024
    v_mfma_f32_16x16x32_bf16 v[116:119], v[180:183], v[84:87], v[116:119]
    s_waitcnt lgkmcnt(1)
    v_cmp_gt_u32 vcc, 2, v66
    s_nop 0
    s_and_b32 s46, vcc_lo, 255
    s_cbranch_scc0 Lp_13
Lp_12:
    s_sleep 1
    ds_read_b32 v66, v19 offset:2048
    s_waitcnt lgkmcnt(0)
    v_cmp_gt_u32 vcc, 2, v66
    s_nop 0
    s_and_b32 s46, vcc_lo, 255
    s_cbranch_scc1 Lp_12
Lp_13:
    s_setprio 3
    v_mfma_f32_16x16x32_bf16 v[112:115], v[152:155], v[88:91], v[112:115]
    ds_read_b128 v[84:87], v3 offset:1088
    v_mfma_f32_16x16x32_bf16 v[116:119], v[184:187], v[88:91], v[116:119]
    ds_read_b64_tr_b16 v[68:69], v6 offset:9216
    v_mfma_f32_16x16x32_bf16 v[112:115], v[156:159], v[92:95], v[112:115]
    ds_read_b128 v[88:91], v3 offset:1152
    v_mfma_f32_16x16x32_bf16 v[116:119], v[188:191], v[92:95], v[116:119]
    ds_read_b64_tr_b16 v[70:71], v6 offset:11520
    v_lshlrev_b32 v9, 1, v7
    v_subrev_u32 v9, s55, v9
    s_waitcnt lgkmcnt(4)
    v_mfma_f32_16x16x32_bf16 v[116:119], v[128:131], v[80:83], v[116:119]
    ds_read_b128 v[92:95], v3 offset:1216
    v_add_u32 v4, 1966080, v7
    global_load_dwordx4 v[28:31], v4, s[4:5]
    v_add_u32 v9, 1310720, v9
    s_waitcnt lgkmcnt(4)
    v_mfma_f32_16x16x32_bf16 v[116:119], v[132:135], v[84:87], v[116:119]
    ds_read_b128 v[80:83], v3 offset:1280
    v_cvt_pk_bf16_f32 v10, v112, v113
    v_cvt_pk_bf16_f32 v11, v114, v115
    s_setprio 2
    s_waitcnt lgkmcnt(3)
    v_mfma_f32_16x16x32_bf16 v[116:119], v[136:139], v[88:91], v[116:119]
    ds_read_b128 v[84:87], v3 offset:1344
    ds_write_b64 v5, v[10:11] offset:18432
    s_waitcnt vmcnt(3)
    v_lshlrev_b32 v74, 16, v20
    s_waitcnt lgkmcnt(3)
    v_mfma_f32_16x16x32_bf16 v[116:119], v[140:143], v[92:95], v[116:119]
    ds_read_b128 v[88:91], v3 offset:1408
    v_and_b32 v75, 0xffff0000, v20
    v_lshlrev_b32 v72, 16, v68
    s_waitcnt lgkmcnt(3)
    v_mfma_f32_16x16x32_bf16 v[116:119], v[144:147], v[80:83], v[116:119]
    ds_read_b128 v[92:95], v3 offset:1472
    v_and_b32 v73, 0xffff0000, v68
    v_mul_f32 v72, v72, v74
    s_waitcnt lgkmcnt(3)
    v_mfma_f32_16x16x32_bf16 v[116:119], v[148:151], v[84:87], v[116:119]
    ds_read_b128 v[80:83], v3 offset:1536
    v_mul_f32 v73, v73, v75
    v_cvt_pk_bf16_f32 v76, v72, v73
    s_waitcnt lgkmcnt(2)
    v_mfma_f32_16x16x32_bf16 v[116:119], v[152:155], v[88:91], v[116:119]
    ds_read_b128 v[84:87], v3 offset:1600
    v_lshlrev_b32 v74, 16, v21
    v_and_b32 v75, 0xffff0000, v21
    s_waitcnt lgkmcnt(2)
    v_mfma_f32_16x16x32_bf16 v[116:119], v[156:159], v[92:95], v[116:119]
    ds_read_b128 v[88:91], v3 offset:1664
    v_lshlrev_b32 v72, 16, v69
    v_and_b32 v73, 0xffff0000, v69
    s_setprio 1
    s_waitcnt lgkmcnt(2)
    v_mfma_f32_16x16x32_bf16 v[120:123], v[192:195], v[80:83], v[120:123]
    ds_read_b128 v[92:95], v3 offset:1728
    v_mul_f32 v72, v72, v74
    v_mul_f32 v73, v73, v75
    v_mfma_f32_16x16x32_bf16 v[124:127], v[224:227], v[80:83], v[124:127]
    v_cvt_pk_bf16_f32 v10, v116, v117
    v_cvt_pk_bf16_f32 v11, v118, v119
    s_waitcnt lgkmcnt(2)
    v_mfma_f32_16x16x32_bf16 v[120:123], v[196:199], v[84:87], v[120:123]
    ds_read_b128 v[80:83], v3 offset:1792
    ds_write_b64 v5, v[10:11] offset:23040
    v_mov_b32 v17, 3
    v_mfma_f32_16x16x32_bf16 v[124:127], v[228:231], v[84:87], v[124:127]
    ds_write_b32 v0, v17 offset:2048
    v_cvt_pk_bf16_f32 v77, v72, v73
    s_waitcnt lgkmcnt(4)
    v_mfma_f32_16x16x32_bf16 v[120:123], v[200:203], v[88:91], v[120:123]
    ds_read_b128 v[84:87], v3 offset:1856
    v_lshlrev_b32 v74, 16, v22
    v_and_b32 v75, 0xffff0000, v22
    v_mfma_f32_16x16x32_bf16 v[124:127], v[232:235], v[88:91], v[124:127]
    v_lshlrev_b32 v72, 16, v70
    v_and_b32 v73, 0xffff0000, v70
    s_setprio 0
    s_waitcnt lgkmcnt(4)
    v_mfma_f32_16x16x32_bf16 v[120:123], v[204:207], v[92:95], v[120:123]
    ds_read_b128 v[88:91], v3 offset:1920
    v_mul_f32 v72, v72, v74
    v_mul_f32 v73, v73, v75
    v_mfma_f32_16x16x32_bf16 v[124:127], v[236:239], v[92:95], v[124:127]
    v_cvt_pk_bf16_f32 v78, v72, v73
    v_lshlrev_b32 v74, 16, v23
    s_waitcnt lgkmcnt(4)
    v_mfma_f32_16x16x32_bf16 v[120:123], v[208:211], v[80:83], v[120:123]
    ds_read_b128 v[92:95], v3 offset:1984
    v_and_b32 v75, 0xffff0000, v23
    v_lshlrev_b32 v72, 16, v71
    v_mfma_f32_16x16x32_bf16 v[124:127], v[240:243], v[80:83], v[124:127]
    ds_read_b32 v66, v19 offset:2048
    v_and_b32 v73, 0xffff0000, v71
    v_mul_f32 v72, v72, v74
    s_waitcnt lgkmcnt(3)
    v_mfma_f32_16x16x32_bf16 v[120:123], v[212:215], v[84:87], v[120:123]
    ds_read_b128 v[80:83], v3 offset:1024
    v_mul_f32 v73, v73, v75
    v_cvt_pk_bf16_f32 v79, v72, v73
    v_mfma_f32_16x16x32_bf16 v[124:127], v[244:247], v[84:87], v[124:127]
    global_store_dwordx4 v9, v[76:79], s[34:35]
    s_waitcnt lgkmcnt(1)
    v_cmp_gt_u32 vcc, 3, v66
    s_nop 0
    s_and_b32 s46, vcc_lo, 255
    s_cbranch_scc0 Lp_15
Lp_14:
    s_sleep 1
    ds_read_b32 v66, v19 offset:2048
    s_waitcnt lgkmcnt(0)
    v_cmp_gt_u32 vcc, 3, v66
    s_nop 0
    s_and_b32 s46, vcc_lo, 255
    s_cbranch_scc1 Lp_14
Lp_15:
    s_setprio 3
    v_mfma_f32_16x16x32_bf16 v[120:123], v[216:219], v[88:91], v[120:123]
    ds_read_b128 v[84:87], v3 offset:1088
    v_mfma_f32_16x16x32_bf16 v[124:127], v[248:251], v[88:91], v[124:127]
    ds_read_b64_tr_b16 v[68:69], v6 offset:18432
    v_mfma_f32_16x16x32_bf16 v[120:123], v[220:223], v[92:95], v[120:123]
    ds_read_b128 v[88:91], v3 offset:1152
    v_mfma_f32_16x16x32_bf16 v[124:127], v[252:255], v[92:95], v[124:127]
    ds_read_b64_tr_b16 v[70:71], v6 offset:20736
    v_lshlrev_b32 v9, 1, v7
    v_subrev_u32 v9, s55, v9
    s_setprio 2
    s_waitcnt lgkmcnt(4)
    v_mfma_f32_16x16x32_bf16 v[120:123], v[160:163], v[80:83], v[120:123]
    ds_read_b128 v[92:95], v3 offset:1216
    v_add_u32 v9, 2621440, v9
    s_waitcnt vmcnt(3)
    v_lshlrev_b32 v74, 16, v24
    v_mfma_f32_16x16x32_bf16 v[124:127], v[192:195], v[80:83], v[124:127]
    v_and_b32 v75, 0xffff0000, v24
    s_setprio 1
    s_waitcnt lgkmcnt(4)
    v_mfma_f32_16x16x32_bf16 v[120:123], v[164:167], v[84:87], v[120:123]
    ds_read_b128 v[80:83], v3 offset:1280
    v_mfma_f32_16x16x32_bf16 v[124:127], v[196:199], v[84:87], v[124:127]
    s_waitcnt lgkmcnt(4)
    v_lshlrev_b32 v72, 16, v68
    v_and_b32 v73, 0xffff0000, v68
    s_waitcnt lgkmcnt(3)
    v_mfma_f32_16x16x32_bf16 v[120:123], v[168:171], v[88:91], v[120:123]
    ds_read_b128 v[84:87], v3 offset:1344
    v_mul_f32 v72, v72, v74
    v_mul_f32 v73, v73, v75
    v_mfma_f32_16x16x32_bf16 v[124:127], v[200:203], v[88:91], v[124:127]
    ds_read_b32 v43, v19 offset:0
    v_cvt_pk_bf16_f32 v76, v72, v73
    v_lshlrev_b32 v74, 16, v25
    s_setprio 0
    s_waitcnt lgkmcnt(3)
    v_mfma_f32_16x16x32_bf16 v[120:123], v[172:175], v[92:95], v[120:123]
    ds_read_b128 v[88:91], v3 offset:1408
    v_and_b32 v75, 0xffff0000, v25
    v_lshlrev_b32 v72, 16, v69
    v_mfma_f32_16x16x32_bf16 v[124:127], v[204:207], v[92:95], v[124:127]
    v_and_b32 v73, 0xffff0000, v69
    v_mul_f32 v72, v72, v74
    s_waitcnt lgkmcnt(1)
    v_cmp_gt_u32 vcc, 4, v43
    s_nop 0
    s_and_b32 s46, vcc_lo, 255
    s_cbranch_scc0 Lp_17
Lp_16:
    s_sleep 1
    ds_read_b32 v43, v19 offset:0
    s_waitcnt lgkmcnt(0)
    v_cmp_gt_u32 vcc, 4, v43
    s_nop 0
    s_and_b32 s46, vcc_lo, 255
    s_cbranch_scc1 Lp_16
Lp_17:
    s_setprio 3
    v_mfma_f32_16x16x32_bf16 v[120:123], v[176:179], v[80:83], v[120:123]
    ds_read_b128 v[92:95], v3 offset:1472
    v_mul_f32 v73, v73, v75
    v_cvt_pk_bf16_f32 v77, v72, v73
    v_mfma_f32_16x16x32_bf16 v[124:127], v[208:211], v[80:83], v[124:127]
    v_lshlrev_b32 v74, 16, v26
    v_and_b32 v75, 0xffff0000, v26
    v_mfma_f32_16x16x32_bf16 v[120:123], v[180:183], v[84:87], v[120:123]
    ds_read_b128 v[80:83], v3 offset:512
    v_lshlrev_b32 v72, 16, v70
    v_and_b32 v73, 0xffff0000, v70
    v_mfma_f32_16x16x32_bf16 v[124:127], v[212:215], v[84:87], v[124:127]
    v_mul_f32 v72, v72, v74
    v_mul_f32 v73, v73, v75
    s_waitcnt lgkmcnt(2)
    v_mfma_f32_16x16x32_bf16 v[120:123], v[184:187], v[88:91], v[120:123]
    ds_read_b128 v[84:87], v3 offset:576
    v_cvt_pk_bf16_f32 v78, v72, v73
    v_lshlrev_b32 v74, 16, v27
    v_mfma_f32_16x16x32_bf16 v[124:127], v[216:219], v[88:91], v[124:127]
    v_and_b32 v75, 0xffff0000, v27
    v_lshlrev_b32 v72, 16, v71
    s_waitcnt lgkmcnt(2)
    v_mfma_f32_16x16x32_bf16 v[120:123], v[188:191], v[92:95], v[120:123]
    ds_read_b128 v[88:91], v3 offset:640
    v_and_b32 v73, 0xffff0000, v71
    v_mul_f32 v72, v72, v74
    v_mfma_f32_16x16x32_bf16 v[124:127], v[220:223], v[92:95], v[124:127]
    v_mul_f32 v73, v73, v75
    v_cvt_pk_bf16_f32 v79, v72, v73
    s_setprio 2
    s_waitcnt lgkmcnt(2)
    v_mfma_f32_16x16x32_bf16 v[120:123], v[128:131], v[80:83], v[120:123]
    ds_read_b128 v[92:95], v3 offset:704
    global_store_dwordx4 v9, v[76:79], s[34:35]
    s_waitcnt vmcnt(2)
    v_lshlrev_b32 v44, 16, v28
    v_mfma_f32_16x16x32_bf16 v[124:127], v[160:163], v[80:83], v[124:127]
    v_and_b32 v45, 0xffff0000, v28
    v_lshlrev_b32 v46, 16, v29
    s_waitcnt lgkmcnt(2)
    v_mfma_f32_16x16x32_bf16 v[120:123], v[132:135], v[84:87], v[120:123]
    ds_read_b128 v[80:83], v3 offset:768
    v_and_b32 v47, 0xffff0000, v29
    v_lshlrev_b32 v48, 16, v30
    v_mfma_f32_16x16x32_bf16 v[124:127], v[164:167], v[84:87], v[124:127]
    v_and_b32 v49, 0xffff0000, v30
    v_lshlrev_b32 v50, 16, v31
    s_waitcnt lgkmcnt(2)
    v_mfma_f32_16x16x32_bf16 v[120:123], v[136:139], v[88:91], v[120:123]
    ds_read_b128 v[84:87], v3 offset:832
    v_and_b32 v51, 0xffff0000, v31
    v_lshlrev_b32 v52, 1, v7
    v_mfma_f32_16x16x32_bf16 v[124:127], v[168:171], v[88:91], v[124:127]
    v_subrev_u32 v52, s55, v52
    v_add_u32 v52, 3932160, v52
    s_waitcnt lgkmcnt(2)
    v_mfma_f32_16x16x32_bf16 v[120:123], v[140:143], v[92:95], v[120:123]
    ds_read_b128 v[88:91], v3 offset:896
    v_mfma_f32_16x16x32_bf16 v[124:127], v[172:175], v[92:95], v[124:127]
    s_setprio 1
    s_waitcnt lgkmcnt(2)
    v_mfma_f32_16x16x32_bf16 v[120:123], v[144:147], v[80:83], v[120:123]
    ds_read_b128 v[92:95], v3 offset:960
    v_mfma_f32_16x16x32_bf16 v[124:127], v[176:179], v[80:83], v[124:127]
    s_waitcnt lgkmcnt(2)
    v_mfma_f32_16x16x32_bf16 v[120:123], v[148:151], v[84:87], v[120:123]
    ds_read_b128 v[80:83], v3 offset:0
    v_mfma_f32_16x16x32_bf16 v[124:127], v[180:183], v[84:87], v[124:127]
    s_waitcnt lgkmcnt(2)
    v_mfma_f32_16x16x32_bf16 v[120:123], v[152:155], v[88:91], v[120:123]
    ds_read_b128 v[84:87], v3 offset:64
    v_mfma_f32_16x16x32_bf16 v[124:127], v[184:187], v[88:91], v[124:127]
    s_waitcnt lgkmcnt(2)
    v_mfma_f32_16x16x32_bf16 v[120:123], v[156:159], v[92:95], v[120:123]
    ds_read_b128 v[88:91], v3 offset:128
    v_mfma_f32_16x16x32_bf16 v[124:127], v[188:191], v[92:95], v[124:127]
    s_setprio 0
    s_waitcnt lgkmcnt(2)
    v_mfma_f32_16x16x32_bf16 v[124:127], v[128:131], v[80:83], v[124:127]
    ds_read_b128 v[92:95], v3 offset:192
    s_waitcnt lgkmcnt(2)
    v_mfma_f32_16x16x32_bf16 v[124:127], v[132:135], v[84:87], v[124:127]
    ds_read_b128 v[80:83], v3 offset:256
    v_cvt_pk_bf16_f32 v10, v120, v121
    v_cvt_pk_bf16_f32 v11, v122, v123
    s_waitcnt lgkmcnt(2)
    v_mfma_f32_16x16x32_bf16 v[124:127], v[136:139], v[88:91], v[124:127]
    ds_read_b128 v[84:87], v3 offset:320
    ds_write_b64 v5, v[10:11] offset:27648
    s_waitcnt lgkmcnt(3)
    v_mfma_f32_16x16x32_bf16 v[124:127], v[140:143], v[92:95], v[124:127]
    ds_read_b128 v[88:91], v3 offset:384
    s_waitcnt lgkmcnt(3)
    v_mfma_f32_16x16x32_bf16 v[124:127], v[144:147], v[80:83], v[124:127]
    ds_read_b128 v[92:95], v3 offset:448
    s_waitcnt lgkmcnt(3)
    v_mfma_f32_16x16x32_bf16 v[124:127], v[148:151], v[84:87], v[124:127]
    s_waitcnt lgkmcnt(1)
    v_mfma_f32_16x16x32_bf16 v[124:127], v[152:155], v[88:91], v[124:127]
    s_waitcnt lgkmcnt(0)
    v_mfma_f32_16x16x32_bf16 v[124:127], v[156:159], v[92:95], v[124:127]
    s_nop 7
    v_cvt_pk_bf16_f32 v10, v124, v125
    v_cvt_pk_bf16_f32 v11, v126, v127
    ds_write_b64 v5, v[10:11] offset:32256
    s_waitcnt lgkmcnt(0)
    s_barrier
    ds_read_b64_tr_b16 v[68:69], v6 offset:27648
    ds_read_b64_tr_b16 v[70:71], v6 offset:29952
    s_waitcnt lgkmcnt(1)
    v_lshlrev_b32 v72, 16, v68
    v_and_b32 v73, 0xffff0000, v68
    v_mul_f32 v72, v72, v44
    v_mul_f32 v73, v73, v45
    v_cvt_pk_bf16_f32 v76, v72, v73
    v_lshlrev_b32 v72, 16, v69
    v_and_b32 v73, 0xffff0000, v69
    v_mul_f32 v72, v72, v46
    v_mul_f32 v73, v73, v47
    v_cvt_pk_bf16_f32 v77, v72, v73
    s_waitcnt lgkmcnt(0)
    v_lshlrev_b32 v72, 16, v70
    v_and_b32 v73, 0xffff0000, v70
    v_mul_f32 v72, v72, v48
    v_mul_f32 v73, v73, v49
    v_cvt_pk_bf16_f32 v78, v72, v73
    v_lshlrev_b32 v72, 16, v71
    v_and_b32 v73, 0xffff0000, v71
    v_mul_f32 v72, v72, v50
    v_mul_f32 v73, v73, v51
    v_cvt_pk_bf16_f32 v79, v72, v73
    global_store_dwordx4 v52, v[76:79], s[34:35]
    s_branch L_fin
L_B:
    s_mul_i32 s44, s57, 13040
    s_add_u32 s3, s44, 4576
    s_mul_i32 s56, s57, 18432
    s_add_u32 s56, s56, 52160
    s_lshl_b32 s48, s57, 6
    v_add_u32 v16, s48, v1
    v_mul_u32_u24 v13, 5120, v16
    v_add_u32 v2, s55, v13
    s_mov_b32 s60, 0x3e22f983
    s_mul_i32 s47, s54, 9216
    s_add_u32 s47, s47, s56
    v_mul_u32_u24 v12, 288, v10
    v_lshl_add_u32 v12, v11, 4, v12
    v_add_u32 v17, s47, v12
    s_sub_u32 s47, s47, 52000
    s_mov_b32 m0, s47
    s_mov_b32 s63, s54
    v_mov_b32 v96, 0
    v_mov_b32 v97, 0
    v_mov_b32 v98, 0
    v_mov_b32 v99, 0
    v_mov_b32 v100, 0
    v_mov_b32 v101, 0
    v_mov_b32 v102, 0
    v_mov_b32 v103, 0
    v_mov_b32 v104, 0
    v_mov_b32 v105, 0
    v_mov_b32 v106, 0
    v_mov_b32 v107, 0
    v_lshlrev_b32 v0, 2, v0
    v_add_u32 v0, 144320, v0
    v_mov_b32 v39, 0
    ds_write_b32 v0, v39
    ds_write_b32 v0, v39 offset:2048
    v_and_b32 v79, 7, v1
    v_mul_u32_u24 v79, 260, v79
    v_add_u32 v79, 144320, v79
    s_waitcnt lgkmcnt(0)
    s_barrier
    s_lshl_b32 s61, 1, s57
    s_lshl_b32 s45, 16, s57
    s_waitcnt vmcnt(1)
    s_mov_b32 s47, 0x3fb8aa3b
    v_mul_f32 v12, s47, v78
    v_fma_f32 v13, v78, s47, -v12
    v_fmamk_f32 v13, v78, 0x32a57060, v13
    v_exp_f32 v12, v12
    v_mul_f32 v13, 0x3f317218, v13
    v_fma_f32 v12, v12, v13, v12
    v_cvt_pk_bf16_f32 v12, v12, v12
    v_and_b32 v12, 0xffff0000, v12
    v_mul_f32 v13, s47, v12
    v_readfirstlane_b32 s58, v12
    v_readfirstlane_b32 s59, v13
    s_cmp_ge_u32 s62, 128
    s_cbranch_scc1 Ls_18
    s_lshr_b32 s48, s62, 1
    s_add_u32 s48, s48, 32
    s_bitcmp0_b32 s62, 0
    s_cselect_b64 s[50:51], s[6:7], s[8:9]
    s_sub_u32 s47, s62, 32
    s_cmp_ge_u32 s62, 64
    s_cselect_b64 s[50:51], s[16:17], s[50:51]
    s_cselect_b32 s48, s47, s48
    s_cselect_b32 s49, s97, s96
    s_cselect_b32 s46, s100, s101
    s_sub_u32 s47, s62, 96
    s_cmp_ge_u32 s62, 96
    s_cselect_b64 s[50:51], s[4:5], s[50:51]
    s_cselect_b32 s48, s47, s48
    s_cselect_b32 s49, s96, s49
    s_cselect_b32 s46, s101, s46
    s_mul_i32 s48, s48, 40960
    s_add_u32 s48, s48, s46
    v_mad_u32_u24 v18, v77, s49, v19
    v_add_u32 v18, s48, v18
    global_load_dword v9, v18, s[50:51]
Ls_18:
    s_sub_u32 s47, s62, 64
    s_cmp_ge_u32 s47, 32
    s_cbranch_scc1 Ls_19
    s_mov_b64 s[50:51], s[4:5]
    s_sub_u32 s48, s62, 32
    s_mov_b32 s49, s96
    s_mov_b32 s46, s101
    s_mul_i32 s48, s48, 40960
    s_add_u32 s48, s48, s46
    v_mad_u32_u24 v18, v77, s49, v19
    v_add_u32 v18, s48, v18
    global_load_dword v9, v18, s[50:51]
Ls_19:
    v_mov_b32 v18, 0x3f80
    s_nop 9
L_kg:
    v_mul_f32 v30, s59, v128
    v_mul_f32 v33, s58, v129
    v_mul_f32 v31, s60, v33
    v_fma_f32 v32, v33, s60, -v31
    v_fmamk_f32 v32, v33, 0x31dc9c88, v32
    v_mul_f32 v130, s58, v130
    v_mul_f32 v131, s58, v131
    v_pk_mul_f32 v[140:141], v[132:133], v[130:131] op_sel:[0,0] op_sel_hi:[0,1]
    v_pk_fma_f32 v[140:141], v[132:133], v[130:131], v[140:141] op_sel:[1,1,0] op_sel_hi:[1,0,1] neg_lo:[1,0,0]
    v_mul_f32 v34, 0x41000000, v30
    v_mul_f32 v36, 0x42800000, v30
    v_mul_f32 v38, 0x43000000, v30
    v_mul_f32 v40, 0x44800000, v30
    v_mul_f32 v42, 0x3f800000, v30
    v_mul_f32 v35, 0x41000000, v31
    v_mul_f32 v37, 0x42800000, v31
    v_mul_f32 v39, 0x43000000, v31
    v_mul_f32 v41, 0x44800000, v31
    v_mul_f32 v43, 0x3f800000, v31
    v_exp_f32 v34, v34
    v_exp_f32 v36, v36
    v_exp_f32 v38, v38
    v_exp_f32 v40, v40
    v_exp_f32 v42, v42
    v_fract_f32 v35, v35
    v_fract_f32 v37, v37
    v_fract_f32 v39, v39
    v_fract_f32 v41, v41
    v_fract_f32 v43, v43
    v_fmamk_f32 v35, v32, 0x41000000, v35
    v_fmamk_f32 v37, v32, 0x42800000, v37
    v_fmamk_f32 v39, v32, 0x43000000, v39
    v_fmamk_f32 v41, v32, 0x44800000, v41
    v_fmamk_f32 v43, v32, 0x3f800000, v43
    v_cos_f32 v148, v35
    v_cos_f32 v150, v37
    v_cos_f32 v152, v39
    v_cos_f32 v154, v41
    v_cos_f32 v156, v43
    v_sin_f32 v149, v35
    v_sin_f32 v151, v37
    v_sin_f32 v153, v39
    v_sin_f32 v155, v41
    v_sin_f32 v157, v43
    v_mul_f32 v148, v148, v34
    v_mul_f32 v150, v150, v36
    v_mul_f32 v152, v152, v38
    v_mul_f32 v154, v154, v40
    v_mul_f32 v156, v156, v42
    v_mul_f32 v149, v149, v34
    v_mul_f32 v151, v151, v36
    v_mul_f32 v153, v153, v38
    v_mul_f32 v155, v155, v40
    v_mul_f32 v157, v157, v42
    v_pk_mul_f32 v[144:145], v[140:141], v[150:151] op_sel:[0,0] op_sel_hi:[0,1]
    v_pk_fma_f32 v[144:145], v[140:141], v[150:151], v[144:145] op_sel:[1,1,0] op_sel_hi:[1,0,1] neg_lo:[1,0,0]
    s_cmp_eq_u32 s54, 0
    s_cbranch_scc1 Ls_20
    global_load_dwordx2 v[112:113], v2, s[16:17] offset:0
Ls_20:
    v_cvt_pk_bf16_f32 v20, v140, -v141
    v_cvt_pk_bf16_f32 v23, v144, -v145
    ds_write_addtid_b32 v18 offset:56608
    v_cvt_pk_bf16_f32 v27, v154, v155
    ds_write_addtid_b32 v20 offset:52000
    ds_write_addtid_b32 v23 offset:54304
    v_cvt_pk_bf16_f32 v24, v152, v153
    ds_write_addtid_b32 v27 offset:58912
    v_pk_mul_f32 v[142:143], v[140:141], v[148:149] op_sel:[0,0] op_sel_hi:[0,1]
    v_pk_mul_f32 v[146:147], v[144:145], v[148:149] op_sel:[0,0] op_sel_hi:[0,1]
    ds_write_addtid_b32 v24 offset:56896
    v_pk_mul_f32 v[164:165], v[154:155], v[152:153] op_sel:[0,0] op_sel_hi:[0,1]
    v_pk_fma_f32 v[142:143], v[140:141], v[148:149], v[142:143] op_sel:[1,1,0] op_sel_hi:[1,0,1] neg_lo:[1,0,0]
    v_pk_fma_f32 v[146:147], v[144:145], v[148:149], v[146:147] op_sel:[1,1,0] op_sel_hi:[1,0,1] neg_lo:[1,0,0]
    v_pk_mul_f32 v[158:159], v[152:153], v[152:153] op_sel:[0,0] op_sel_hi:[0,1]
    v_pk_fma_f32 v[164:165], v[154:155], v[152:153], v[164:165] op_sel:[1,1,0] op_sel_hi:[1,0,1] neg_lo:[1,0,0]
    v_cvt_pk_bf16_f32 v20, v142, -v143
    v_cvt_pk_bf16_f32 v23, v146, -v147
    v_pk_fma_f32 v[158:159], v[152:153], v[152:153], v[158:159] op_sel:[1,1,0] op_sel_hi:[1,0,1] neg_lo:[1,0,0]
    v_cvt_pk_bf16_f32 v26, v164, v165
    ds_write_addtid_b32 v20 offset:52288
    ds_write_addtid_b32 v23 offset:54592
    v_cvt_pk_bf16_f32 v25, v158, v159
    ds_write_addtid_b32 v26 offset:59200
    v_pk_mul_f32 v[140:141], v[142:143], v[148:149] op_sel:[0,0] op_sel_hi:[0,1]
    v_pk_mul_f32 v[144:145], v[146:147], v[148:149] op_sel:[0,0] op_sel_hi:[0,1]
    ds_write_addtid_b32 v25 offset:57184
    v_pk_mul_f32 v[162:163], v[164:165], v[152:153] op_sel:[0,0] op_sel_hi:[0,1]
    v_pk_fma_f32 v[140:141], v[142:143], v[148:149], v[140:141] op_sel:[1,1,0] op_sel_hi:[1,0,1] neg_lo:[1,0,0]
    v_pk_fma_f32 v[144:145], v[146:147], v[148:149], v[144:145] op_sel:[1,1,0] op_sel_hi:[1,0,1] neg_lo:[1,0,0]
    v_pk_mul_f32 v[160:161], v[158:159], v[152:153] op_sel:[0,0] op_sel_hi:[0,1]
    v_pk_fma_f32 v[162:163], v[164:165], v[152:153], v[162:163] op_sel:[1,1,0] op_sel_hi:[1,0,1] neg_lo:[1,0,0]
    v_cvt_pk_bf16_f32 v20, v140, -v141
    v_cvt_pk_bf16_f32 v23, v144, -v145
    v_pk_fma_f32 v[160:161], v[158:159], v[152:153], v[160:161] op_sel:[1,1,0] op_sel_hi:[1,0,1] neg_lo:[1,0,0]
    v_cvt_pk_bf16_f32 v27, v162, v163
    ds_write_addtid_b32 v20 offset:52576
    ds_write_addtid_b32 v23 offset:54880
    v_cvt_pk_bf16_f32 v24, v160, v161
    ds_write_addtid_b32 v27 offset:59488
    v_pk_mul_f32 v[142:143], v[140:141], v[148:149] op_sel:[0,0] op_sel_hi:[0,1]
    v_pk_mul_f32 v[146:147], v[144:145], v[148:149] op_sel:[0,0] op_sel_hi:[0,1]
    ds_write_addtid_b32 v24 offset:57472
    v_pk_mul_f32 v[164:165], v[162:163], v[152:153] op_sel:[0,0] op_sel_hi:[0,1]
    v_pk_fma_f32 v[142:143], v[140:141], v[148:149], v[142:143] op_sel:[1,1,0] op_sel_hi:[1,0,1] neg_lo:[1,0,0]
    v_pk_fma_f32 v[146:147], v[144:145], v[148:149], v[146:147] op_sel:[1,1,0] op_sel_hi:[1,0,1] neg_lo:[1,0,0]
    v_pk_mul_f32 v[158:159], v[160:161], v[152:153] op_sel:[0,0] op_sel_hi:[0,1]
    v_pk_fma_f32 v[164:165], v[162:163], v[152:153], v[164:165] op_sel:[1,1,0] op_sel_hi:[1,0,1] neg_lo:[1,0,0]
    v_cvt_pk_bf16_f32 v20, v142, -v143
    v_cvt_pk_bf16_f32 v23, v146, -v147
    v_pk_fma_f32 v[158:159], v[160:161], v[152:153], v[158:159] op_sel:[1,1,0] op_sel_hi:[1,0,1] neg_lo:[1,0,0]
    v_cvt_pk_bf16_f32 v26, v164, v165
    ds_write_addtid_b32 v20 offset:52864
    ds_write_addtid_b32 v23 offset:55168
    v_cvt_pk_bf16_f32 v25, v158, v159
    ds_write_addtid_b32 v26 offset:59776
    v_pk_mul_f32 v[140:141], v[142:143], v[148:149] op_sel:[0,0] op_sel_hi:[0,1]
    v_pk_mul_f32 v[144:145], v[146:147], v[148:149] op_sel:[0,0] op_sel_hi:[0,1]
    ds_write_addtid_b32 v25 offset:57760
    v_pk_mul_f32 v[162:163], v[164:165], v[152:153] op_sel:[0,0] op_sel_hi:[0,1]
    v_pk_fma_f32 v[140:141], v[142:143], v[148:149], v[140:141] op_sel:[1,1,0] op_sel_hi:[1,0,1] neg_lo:[1,0,0]
    v_pk_fma_f32 v[144:145], v[146:147], v[148:149], v[144:145] op_sel:[1,1,0] op_sel_hi:[1,0,1] neg_lo:[1,0,0]
    v_pk_mul_f32 v[160:161], v[158:159], v[152:153] op_sel:[0,0] op_sel_hi:[0,1]
    v_pk_fma_f32 v[162:163], v[164:165], v[152:153], v[162:163] op_sel:[1,1,0] op_sel_hi:[1,0,1] neg_lo:[1,0,0]
    s_cmp_eq_u32 s54, 0
    s_cbranch_scc1 Ls_21
    global_load_dwordx2 v[114:115], v2, s[16:17] offset:1280
Ls_21:
    v_cvt_pk_bf16_f32 v20, v140, -v141
    v_cvt_pk_bf16_f32 v23, v144, -v145
    v_pk_fma_f32 v[160:161], v[158:159], v[152:153], v[160:161] op_sel:[1,1,0] op_sel_hi:[1,0,1] neg_lo:[1,0,0]
    v_cvt_pk_bf16_f32 v27, v162, v163
    ds_write_addtid_b32 v20 offset:53152
    ds_write_addtid_b32 v23 offset:55456
    v_cvt_pk_bf16_f32 v24, v160, v161
    ds_write_addtid_b32 v27 offset:60064
    v_pk_mul_f32 v[142:143], v[140:141], v[148:149] op_sel:[0,0] op_sel_hi:[0,1]
    v_pk_mul_f32 v[146:147], v[144:145], v[148:149] op_sel:[0,0] op_sel_hi:[0,1]
    ds_write_addtid_b32 v24 offset:58048
    v_pk_mul_f32 v[164:165], v[162:163], v[152:153] op_sel:[0,0] op_sel_hi:[0,1]
    v_pk_fma_f32 v[142:143], v[140:141], v[148:149], v[142:143] op_sel:[1,1,0] op_sel_hi:[1,0,1] neg_lo:[1,0,0]
    v_pk_fma_f32 v[146:147], v[144:145], v[148:149], v[146:147] op_sel:[1,1,0] op_sel_hi:[1,0,1] neg_lo:[1,0,0]
    v_pk_mul_f32 v[158:159], v[160:161], v[152:153] op_sel:[0,0] op_sel_hi:[0,1]
    v_pk_fma_f32 v[164:165], v[162:163], v[152:153], v[164:165] op_sel:[1,1,0] op_sel_hi:[1,0,1] neg_lo:[1,0,0]
    v_cvt_pk_bf16_f32 v20, v142, -v143
    v_cvt_pk_bf16_f32 v23, v146, -v147
    v_pk_fma_f32 v[158:159], v[160:161], v[152:153], v[158:159] op_sel:[1,1,0] op_sel_hi:[1,0,1] neg_lo:[1,0,0]
    v_cvt_pk_bf16_f32 v26, v164, v165
    ds_write_addtid_b32 v20 offset:53440
    ds_write_addtid_b32 v23 offset:55744
    v_cvt_pk_bf16_f32 v25, v158, v159
    ds_write_addtid_b32 v26 offset:60352
    v_pk_mul_f32 v[140:141], v[142:143], v[148:149] op_sel:[0,0] op_sel_hi:[0,1]
    v_pk_mul_f32 v[144:145], v[146:147], v[148:149] op_sel:[0,0] op_sel_hi:[0,1]
    ds_write_addtid_b32 v25 offset:58336
    v_pk_mul_f32 v[162:163], v[164:165], v[152:153] op_sel:[0,0] op_sel_hi:[0,1]
    v_pk_fma_f32 v[140:141], v[142:143], v[148:149], v[140:141] op_sel:[1,1,0] op_sel_hi:[1,0,1] neg_lo:[1,0,0]
    v_pk_fma_f32 v[144:145], v[146:147], v[148:149], v[144:145] op_sel:[1,1,0] op_sel_hi:[1,0,1] neg_lo:[1,0,0]
    v_pk_mul_f32 v[160:161], v[158:159], v[152:153] op_sel:[0,0] op_sel_hi:[0,1]
    v_pk_fma_f32 v[162:163], v[164:165], v[152:153], v[162:163] op_sel:[1,1,0] op_sel_hi:[1,0,1] neg_lo:[1,0,0]
    v_cvt_pk_bf16_f32 v20, v140, -v141
    v_cvt_pk_bf16_f32 v23, v144, -v145
    v_pk_fma_f32 v[160:161], v[158:159], v[152:153], v[160:161] op_sel:[1,1,0] op_sel_hi:[1,0,1] neg_lo:[1,0,0]
    v_cvt_pk_bf16_f32 v27, v162, v163
    ds_write_addtid_b32 v20 offset:53728
    ds_write_addtid_b32 v23 offset:56032
    v_cvt_pk_bf16_f32 v24, v160, v161
    ds_write_addtid_b32 v27 offset:60640
    v_pk_mul_f32 v[142:143], v[140:141], v[148:149] op_sel:[0,0] op_sel_hi:[0,1]
    v_pk_mul_f32 v[146:147], v[144:145], v[148:149] op_sel:[0,0] op_sel_hi:[0,1]
    ds_write_addtid_b32 v24 offset:58624
    v_pk_mul_f32 v[164:165], v[162:163], v[152:153] op_sel:[0,0] op_sel_hi:[0,1]
    v_pk_fma_f32 v[142:143], v[140:141], v[148:149], v[142:143] op_sel:[1,1,0] op_sel_hi:[1,0,1] neg_lo:[1,0,0]
    v_pk_fma_f32 v[146:147], v[144:145], v[148:149], v[146:147] op_sel:[1,1,0] op_sel_hi:[1,0,1] neg_lo:[1,0,0]
    v_pk_fma_f32 v[164:165], v[162:163], v[152:153], v[164:165] op_sel:[1,1,0] op_sel_hi:[1,0,1] neg_lo:[1,0,0]
    v_cvt_pk_bf16_f32 v20, v142, -v143
    v_cvt_pk_bf16_f32 v23, v146, -v147
    v_cvt_pk_bf16_f32 v26, v164, v165
    ds_write_addtid_b32 v20 offset:54016
    ds_write_addtid_b32 v23 offset:56320
    ds_write_addtid_b32 v26 offset:60928
    s_cmp_eq_u32 s54, 0
    s_cbranch_scc1 Ls_22
    global_load_dwordx2 v[116:117], v2, s[16:17] offset:2560
Ls_22:
    ds_read_b128 v[44:47], v17 offset:0
    ds_read_b128 v[48:51], v17 offset:64
    ds_read_b128 v[52:55], v17 offset:128
    ds_read_b128 v[56:59], v17 offset:192
    ds_read_b128 v[60:63], v17 offset:4608
    ds_read_b128 v[64:67], v17 offset:4672
    ds_read_b128 v[68:71], v17 offset:4736
    ds_read_b128 v[72:75], v17 offset:4800
    v_pk_mul_f32 v[166:167], v[156:157], v[156:157] op_sel:[0,0] op_sel_hi:[0,1]
    v_pk_mul_f32 v[180:181], v[164:165], v[152:153] op_sel:[0,0] op_sel_hi:[0,1]
    v_pk_fma_f32 v[166:167], v[156:157], v[156:157], v[166:167] op_sel:[1,1,0] op_sel_hi:[1,0,1] neg_lo:[1,0,0]
    v_pk_fma_f32 v[180:181], v[164:165], v[152:153], v[180:181] op_sel:[1,1,0] op_sel_hi:[1,0,1] neg_lo:[1,0,0]
    v_cvt_pk_bf16_f32 v21, v180, v181
    ds_write_addtid_b32 v21 offset:58912
    v_pk_mul_f32 v[170:171], v[166:167], v[166:167] op_sel:[0,0] op_sel_hi:[0,1]
    v_pk_mul_f32 v[168:169], v[166:167], v[156:157] op_sel:[0,0] op_sel_hi:[0,1]
    v_cvt_pk_bf16_f32 v24, v156, v157
    v_pk_mul_f32 v[178:179], v[152:153], v[156:157] op_sel:[0,0] op_sel_hi:[0,1]
    v_pk_fma_f32 v[170:171], v[166:167], v[166:167], v[170:171] op_sel:[1,1,0] op_sel_hi:[1,0,1] neg_lo:[1,0,0]
    v_pk_fma_f32 v[168:169], v[166:167], v[156:157], v[168:169] op_sel:[1,1,0] op_sel_hi:[1,0,1] neg_lo:[1,0,0]
    ds_write_addtid_b32 v24 offset:52000
    v_pk_fma_f32 v[178:179], v[152:153], v[156:157], v[178:179] op_sel:[1,1,0] op_sel_hi:[1,0,1] neg_lo:[1,0,0]
    v_cvt_pk_bf16_f32 v20, v170, v171
    v_cvt_pk_bf16_f32 v23, v168, v169
    v_cvt_pk_bf16_f32 v25, v166, v167
    v_cvt_pk_bf16_f32 v26, v178, v179
    ds_write_addtid_b32 v20 offset:56608
    ds_write_addtid_b32 v23 offset:53152
    ds_write_addtid_b32 v25 offset:54304
    ds_write_addtid_b32 v26 offset:52576
    v_pk_mul_f32 v[182:183], v[170:171], v[152:153] op_sel:[0,0] op_sel_hi:[0,1]
    v_pk_mul_f32 v[172:173], v[170:171], v[156:157] op_sel:[0,0] op_sel_hi:[0,1]
    v_pk_mul_f32 v[184:185], v[152:153], v[166:167] op_sel:[0,0] op_sel_hi:[0,1]
    v_pk_mul_f32 v[174:175], v[170:171], v[166:167] op_sel:[0,0] op_sel_hi:[0,1]
    v_pk_fma_f32 v[182:183], v[170:171], v[152:153], v[182:183] op_sel:[1,1,0] op_sel_hi:[1,0,1] neg_lo:[1,0,0]
    v_pk_fma_f32 v[172:173], v[170:171], v[156:157], v[172:173] op_sel:[1,1,0] op_sel_hi:[1,0,1] neg_lo:[1,0,0]
    v_pk_fma_f32 v[184:185], v[152:153], v[166:167], v[184:185] op_sel:[1,1,0] op_sel_hi:[1,0,1] neg_lo:[1,0,0]
    v_pk_fma_f32 v[174:175], v[170:171], v[166:167], v[174:175] op_sel:[1,1,0] op_sel_hi:[1,0,1] neg_lo:[1,0,0]
    v_cvt_pk_bf16_f32 v21, v182, v183
    v_cvt_pk_bf16_f32 v22, v172, v173
    v_cvt_pk_bf16_f32 v25, v184, v185
    v_cvt_pk_bf16_f32 v26, v174, v175
    ds_write_addtid_b32 v21 offset:56896
    ds_write_addtid_b32 v22 offset:52288
    ds_write_addtid_b32 v25 offset:54880
    ds_write_addtid_b32 v26 offset:54592
    v_pk_mul_f32 v[180:181], v[182:183], v[152:153] op_sel:[0,0] op_sel_hi:[0,1]
    v_pk_mul_f32 v[176:177], v[170:171], v[168:169] op_sel:[0,0] op_sel_hi:[0,1]
    v_pk_mul_f32 v[186:187], v[152:153], v[184:185] op_sel:[0,0] op_sel_hi:[0,1]
    v_pk_mul_f32 v[188:189], v[152:153], v[174:175] op_sel:[0,0] op_sel_hi:[0,1]
    v_pk_fma_f32 v[180:181], v[182:183], v[152:153], v[180:181] op_sel:[1,1,0] op_sel_hi:[1,0,1] neg_lo:[1,0,0]
    v_pk_fma_f32 v[176:177], v[170:171], v[168:169], v[176:177] op_sel:[1,1,0] op_sel_hi:[1,0,1] neg_lo:[1,0,0]
    v_pk_fma_f32 v[186:187], v[152:153], v[184:185], v[186:187] op_sel:[1,1,0] op_sel_hi:[1,0,1] neg_lo:[1,0,0]
    v_pk_fma_f32 v[188:189], v[152:153], v[174:175], v[188:189] op_sel:[1,1,0] op_sel_hi:[1,0,1] neg_lo:[1,0,0]
    v_cvt_pk_bf16_f32 v20, v180, v181
    v_cvt_pk_bf16_f32 v23, v176, v177
    v_cvt_pk_bf16_f32 v24, v186, v187
    v_cvt_pk_bf16_f32 v27, v188, v189
    ds_write_addtid_b32 v20 offset:57184
    ds_write_addtid_b32 v23 offset:53440
    ds_write_addtid_b32 v24 offset:55456
    ds_write_addtid_b32 v27 offset:55168
    v_pk_mul_f32 v[182:183], v[180:181], v[152:153] op_sel:[0,0] op_sel_hi:[0,1]
    v_pk_mul_f32 v[178:179], v[152:153], v[172:173] op_sel:[0,0] op_sel_hi:[0,1]
    v_pk_mul_f32 v[184:185], v[152:153], v[186:187] op_sel:[0,0] op_sel_hi:[0,1]
    v_pk_mul_f32 v[174:175], v[152:153], v[188:189] op_sel:[0,0] op_sel_hi:[0,1]
    v_pk_fma_f32 v[182:183], v[180:181], v[152:153], v[182:183] op_sel:[1,1,0] op_sel_hi:[1,0,1] neg_lo:[1,0,0]
    v_pk_fma_f32 v[178:179], v[152:153], v[172:173], v[178:179] op_sel:[1,1,0] op_sel_hi:[1,0,1] neg_lo:[1,0,0]
    v_pk_fma_f32 v[184:185], v[152:153], v[186:187], v[184:185] op_sel:[1,1,0] op_sel_hi:[1,0,1] neg_lo:[1,0,0]
    v_pk_fma_f32 v[174:175], v[152:153], v[188:189], v[174:175] op_sel:[1,1,0] op_sel_hi:[1,0,1] neg_lo:[1,0,0]
    v_cvt_pk_bf16_f32 v21, v182, v183
    v_cvt_pk_bf16_f32 v22, v178, v179
    v_cvt_pk_bf16_f32 v25, v184, v185
    v_cvt_pk_bf16_f32 v26, v174, v175
    ds_write_addtid_b32 v21 offset:57472
    ds_write_addtid_b32 v22 offset:52864
    ds_write_addtid_b32 v25 offset:56032
    ds_write_addtid_b32 v26 offset:55744
    v_pk_mul_f32 v[180:181], v[182:183], v[152:153] op_sel:[0,0] op_sel_hi:[0,1]
    v_pk_mul_f32 v[178:179], v[152:153], v[168:169] op_sel:[0,0] op_sel_hi:[0,1]
    v_pk_mul_f32 v[188:189], v[152:153], v[174:175] op_sel:[0,0] op_sel_hi:[0,1]
    v_pk_fma_f32 v[180:181], v[182:183], v[152:153], v[180:181] op_sel:[1,1,0] op_sel_hi:[1,0,1] neg_lo:[1,0,0]
    v_pk_fma_f32 v[178:179], v[152:153], v[168:169], v[178:179] op_sel:[1,1,0] op_sel_hi:[1,0,1] neg_lo:[1,0,0]
    v_pk_fma_f32 v[188:189], v[152:153], v[174:175], v[188:189] op_sel:[1,1,0] op_sel_hi:[1,0,1] neg_lo:[1,0,0]
    v_cvt_pk_bf16_f32 v20, v180, v181
    v_cvt_pk_bf16_f32 v23, v178, v179
    v_cvt_pk_bf16_f32 v27, v188, v189
    ds_write_addtid_b32 v20 offset:57760
    ds_write_addtid_b32 v23 offset:53728
    ds_write_addtid_b32 v27 offset:56320
    v_pk_mul_f32 v[182:183], v[180:181], v[152:153] op_sel:[0,0] op_sel_hi:[0,1]
    v_pk_mul_f32 v[178:179], v[152:153], v[176:177] op_sel:[0,0] op_sel_hi:[0,1]
    v_pk_fma_f32 v[182:183], v[180:181], v[152:153], v[182:183] op_sel:[1,1,0] op_sel_hi:[1,0,1] neg_lo:[1,0,0]
    v_pk_fma_f32 v[178:179], v[152:153], v[176:177], v[178:179] op_sel:[1,1,0] op_sel_hi:[1,0,1] neg_lo:[1,0,0]
    v_cvt_pk_bf16_f32 v21, v182, v183
    v_cvt_pk_bf16_f32 v22, v178, v179
    ds_write_addtid_b32 v21 offset:58048
    ds_write_addtid_b32 v22 offset:54016
    v_pk_mul_f32 v[180:181], v[182:183], v[152:153] op_sel:[0,0] op_sel_hi:[0,1]
    v_pk_fma_f32 v[180:181], v[182:183], v[152:153], v[180:181] op_sel:[1,1,0] op_sel_hi:[1,0,1] neg_lo:[1,0,0]
    v_cvt_pk_bf16_f32 v20, v180, v181
    ds_write_addtid_b32 v20 offset:58336
    v_pk_mul_f32 v[182:183], v[180:181], v[152:153] op_sel:[0,0] op_sel_hi:[0,1]
    v_pk_fma_f32 v[182:183], v[180:181], v[152:153], v[182:183] op_sel:[1,1,0] op_sel_hi:[1,0,1] neg_lo:[1,0,0]
    v_cvt_pk_bf16_f32 v21, v182, v183
    ds_write_addtid_b32 v21 offset:58624
    ds_read_b128 v[208:211], v17 offset:0
    ds_read_b128 v[212:215], v17 offset:64
    ds_read_b128 v[216:219], v17 offset:128
    ds_read_b128 v[220:223], v17 offset:192
    ds_read_b128 v[224:227], v17 offset:4608
    ds_read_b128 v[228:231], v17 offset:4672
    ds_read_b128 v[232:235], v17 offset:4736
    ds_read_b128 v[236:239], v17 offset:4800
    s_waitcnt lgkmcnt(15)
    v_mfma_f32_16x16x32_bf16 v[96:99], v[60:63], v[44:47], v[96:99]
    s_waitcnt lgkmcnt(15)
    v_mfma_f32_16x16x32_bf16 v[96:99], v[64:67], v[48:51], v[96:99]
    s_waitcnt lgkmcnt(15)
    v_mfma_f32_16x16x32_bf16 v[96:99], v[68:71], v[52:55], v[96:99]
    s_waitcnt lgkmcnt(15)
    v_mfma_f32_16x16x32_bf16 v[96:99], v[72:75], v[56:59], v[96:99]
    s_waitcnt lgkmcnt(7)
    v_mfma_f32_16x16x32_bf16 v[100:103], v[208:211], v[44:47], v[100:103]
    s_waitcnt lgkmcnt(6)
    v_mfma_f32_16x16x32_bf16 v[100:103], v[212:215], v[48:51], v[100:103]
    s_waitcnt lgkmcnt(5)
    v_mfma_f32_16x16x32_bf16 v[100:103], v[216:219], v[52:55], v[100:103]
    s_waitcnt lgkmcnt(4)
    v_mfma_f32_16x16x32_bf16 v[100:103], v[220:223], v[56:59], v[100:103]
    s_waitcnt lgkmcnt(3)
    v_mfma_f32_16x16x32_bf16 v[104:107], v[224:227], v[44:47], v[104:107]
    s_waitcnt lgkmcnt(2)
    v_mfma_f32_16x16x32_bf16 v[104:107], v[228:231], v[48:51], v[104:107]
    s_waitcnt lgkmcnt(1)
    v_mfma_f32_16x16x32_bf16 v[104:107], v[232:235], v[52:55], v[104:107]
    s_waitcnt lgkmcnt(0)
    v_mfma_f32_16x16x32_bf16 v[104:107], v[236:239], v[56:59], v[104:107]
    v_lshlrev_b32 v12, 4, v1
    v_add_u32 v12, s56, v12
    s_cmp_lg_u32 s54, 0
    s_cbranch_scc1 L_BH
    v_mov_b32 v128, v134
    v_mov_b32 v129, v135
    v_mov_b32 v130, v136
    v_mov_b32 v131, v137
    v_mov_b32 v132, v138
    v_mov_b32 v133, v139
    s_add_u32 s63, s63, 1
    s_cmp_lt_u32 s63, 2
    s_cbranch_scc1 L_kg
    s_waitcnt vmcnt(0)
    v_not_b32 v12, v10
    v_and_b32 v12, 3, v12
    v_mul_u32_u24 v13, 2114, v12
    v_lshl_add_u32 v14, v11, 3, v10
    v_lshl_add_u32 v13, v14, 1, v13
    s_add_u32 s47, s3, 2
    v_add_u32 v2, s47, v13
    v_lshlrev_b32 v12, 4, v11
    v_lshlrev_b32 v13, 5, v10
    v_sub_u32 v12, v12, v13
    s_add_u32 s47, s44, 480
    v_add_u32 v3, s47, v12
    v_lshlrev_b32 v14, 4, v1
    s_add_u32 s47, s3, 32
    v_add_u32 v8, s47, v14
    v_lshlrev_b32 v12, 5, v10
    v_lshlrev_b32 v14, 7, v11
    v_sub_u32 v12, v12, v14
    s_add_u32 s47, s56, 1968
    v_add_u32 v4, s47, v12
    v_mul_u32_u24 v15, 272, v10
    v_lshl_add_u32 v15, v11, 4, v15
    s_add_u32 s47, s56, 12288
    v_add_u32 v7, s47, v15
    v_lshl_add_u32 v12, v11, 3, v10
    v_lshlrev_b32 v12, 1, v12
    s_add_u32 s47, s56, 5248
    v_add_u32 v6, s47, v12
    v_add_u32 v12, 1009, v1
    v_bfe_u32 v13, v12, 2, 1
    v_add3_u32 v12, v12, v13, 1
    v_and_b32 v12, 0xfffffffc, v12
    v_min_u32 v12, 1024, v12
    v_lshlrev_b32 v12, 1, v12
    v_add_u32 v16, s56, v12
    v_lshlrev_b32 v12, 5, v10
    v_lshl_add_u32 v12, v11, 3, v12
    s_mul_i32 s47, s57, 576
    s_add_u32 s47, s47, 125888
    v_add_u32 v5, s47, v12
    v_lshlrev_b32 v12, 4, v1
    v_add_u32 v12, s56, v12
    ds_read_b32 v39, v79 offset:0
    s_waitcnt lgkmcnt(0)
    v_cmp_gt_u32 vcc, 1, v39
    s_nop 0
    s_and_b32 s46, vcc_lo, s45
    s_cbranch_scc0 Lp_24
Lp_23:
    s_sleep 1
    ds_read_b32 v39, v79 offset:0
    s_waitcnt lgkmcnt(0)
    v_cmp_gt_u32 vcc, 1, v39
    s_nop 0
    s_and_b32 s46, vcc_lo, s45
    s_cbranch_scc1 Lp_23
Lp_24:
    ds_read_b128 v[44:47], v12 offset:9216
    ds_read_b128 v[48:51], v12 offset:10240
    ds_read_b128 v[52:55], v12 offset:11264
    v_lshlrev_b32 v12, 4, v10
    v_add_u32 v12, s56, v12
    v_lshl_add_u32 v13, v11, 10, v12
    v_mov_b32 v14, 2
    v_cmp_eq_u32 vcc, 1, v11
    v_mov_b32 v15, 8
    v_mov_b32 v19, 1032
    v_cndmask_b32 v14, v14, 6, vcc
    v_cndmask_b32 v15, v15, v19, vcc
    v_cmp_eq_u32 vcc, 2, v11
    v_mov_b32 v19, 4096
    s_nop 0
    v_cndmask_b32 v14, v14, 4, vcc
    v_cndmask_b32 v15, v15, v19, vcc
    v_cmp_eq_u32 vcc, 3, v11
    v_mov_b32 v18, 516
    v_mov_b32 v19, 4104
    v_cndmask_b32 v14, v14, v18, vcc
    v_cndmask_b32 v15, v15, v19, vcc
    v_add_u32 v14, v14, v12
    v_add_u32 v15, v15, v12
    s_waitcnt lgkmcnt(2)
    v_add_f32 v96, v96, v44
    v_add_f32 v97, v97, v45
    v_add_f32 v98, v98, v46
    v_add_f32 v99, v99, v47
    s_waitcnt lgkmcnt(1)
    v_add_f32 v100, v100, v48
    v_add_f32 v101, v101, v49
    v_add_f32 v102, v102, v50
    v_add_f32 v103, v103, v51
    s_waitcnt lgkmcnt(0)
    v_add_f32 v104, v104, v52
    v_add_f32 v105, v105, v53
    v_add_f32 v106, v106, v54
    v_add_f32 v107, v107, v55
    s_mov_b64 exec, 1
    v_add_f32 v96, v96, v76
    s_mov_b64 exec, -1
    v_cvt_pk_bf16_f32 v20, v96, v97
    ds_write_b16 v13, v20 offset:0
    ds_write_b16_d16_hi v13, v20 offset:256
    v_cvt_pk_bf16_f32 v21, v98, v99
    ds_write_b16 v13, v21 offset:512
    ds_write_b16_d16_hi v13, v21 offset:768
    v_cvt_pk_bf16_f32 v22, v100, v101
    ds_write_b16 v14, v22 offset:0
    ds_write_b16_d16_hi v14, v22 offset:8
    v_cvt_pk_bf16_f32 v23, v102, v103
    ds_write_b16 v14, v23 offset:256
    ds_write_b16_d16_hi v14, v23 offset:264
    v_cvt_pk_bf16_f32 v24, v104, v105
    ds_write_b16 v15, v24 offset:0
    ds_write_b16_d16_hi v15, v24 offset:256
    v_cvt_pk_bf16_f32 v25, v106, v107
    ds_write_b16 v15, v25 offset:512
    ds_write_b16_d16_hi v15, v25 offset:768
    v_lshlrev_b32 v12, 4, v1
    v_add_u32 v12, s56, v12
    v_lshrrev_b32 v13, 5, v1
    v_lshlrev_b32 v13, 1, v13
    v_sub_u32 v14, v12, v13
    v_add_u32 v15, v12, v13
    ds_read_u16 v30, v12 offset:0
    ds_read_u16 v31, v14 offset:2
    ds_read_u16 v32, v12 offset:4
    ds_read_u16 v33, v15 offset:6
    ds_read_u16 v34, v12 offset:8
    ds_read_u16 v35, v14 offset:10
    ds_read_u16 v36, v12 offset:12
    ds_read_u16 v37, v15 offset:14
    ds_read_u16 v26, v12 offset:1024
    ds_read_u16 v27, v12 offset:1032
    ds_read_u16 v28, v12 offset:1040
    ds_read_u16 v38, v16
    ds_read_b32 v39, v79 offset:0
    v_mov_b32 v20, 0
    v_mov_b32 v21, 0
    v_mov_b32 v22, 0
    v_mov_b32 v23, 0
    s_mov_b32 exec_hi, 0
    ds_write_b128 v12, v[20:23] offset:1552
    s_mov_b64 exec, -1
    v_cmp_gt_u32 vcc, 20, v1
    v_lshlrev_b32 v13, 1, v1
    v_add_u32 v13, s56, v13
    s_waitcnt lgkmcnt(2)
    v_cndmask_b32 v38, 0, v38, vcc
    ds_write_b16 v13, v38 offset:5248
    v_lshl_or_b32 v48, v31, 16, v30
    v_lshl_or_b32 v49, v33, 16, v32
    v_lshl_or_b32 v50, v35, 16, v34
    v_lshl_or_b32 v51, v37, 16, v36
    v_lshl_or_b32 v54, v26, 16, v26
    v_lshl_or_b32 v55, v27, 16, v26
    v_lshl_or_b32 v56, v27, 16, v27
    v_lshl_or_b32 v57, v28, 16, v28
    v_mov_b32_dpp v52, v50 wave_ror:1 row_mask:0xf bank_mask:0xf
    v_mov_b32_dpp v53, v51 wave_ror:1 row_mask:0xf bank_mask:0xf
    s_nop 0
    v_mov_b32_dpp v52, v56 wave_shr:1 row_mask:0xf bank_mask:0xf
    v_mov_b32_dpp v53, v57 wave_shr:1 row_mask:0xf bank_mask:0xf
    v_mov_b32 v46, 0
    v_mov_b32 v47, 0
    s_nop 0
    v_mov_b32_dpp v46, v50 wave_shr:1 row_mask:0xf bank_mask:0xf
    v_mov_b32_dpp v47, v51 wave_shr:1 row_mask:0xf bank_mask:0xf
    ds_write_b128 v8, v[48:51] offset:0
    v_alignbit_b32 v64, v48, v47, 16
    v_alignbit_b32 v65, v49, v48, 16
    v_alignbit_b32 v66, v50, v49, 16
    v_alignbit_b32 v67, v51, v50, 16
    ds_write_b128 v8, v[64:67] offset:2112
    v_mov_b32 v60, v47
    v_mov_b32 v61, v48
    v_mov_b32 v62, v49
    v_mov_b32 v63, v50
    ds_write_b128 v8, v[60:63] offset:4224
    v_alignbit_b32 v68, v47, v46, 16
    v_alignbit_b32 v69, v48, v47, 16
    v_alignbit_b32 v70, v49, v48, 16
    v_alignbit_b32 v71, v50, v49, 16
    ds_write_b128 v8, v[68:71] offset:6336
    ds_write_b128 v8, v[54:57] offset:1024
    v_alignbit_b32 v64, v54, v53, 16
    v_alignbit_b32 v65, v55, v54, 16
    v_alignbit_b32 v66, v56, v55, 16
    v_alignbit_b32 v67, v57, v56, 16
    ds_write_b128 v8, v[64:67] offset:3136
    v_mov_b32 v60, v53
    v_mov_b32 v61, v54
    v_mov_b32 v62, v55
    v_mov_b32 v63, v56
    ds_write_b128 v8, v[60:63] offset:5248
    v_alignbit_b32 v68, v53, v52, 16
    v_alignbit_b32 v69, v54, v53, 16
    v_alignbit_b32 v70, v55, v54, 16
    v_alignbit_b32 v71, v56, v55, 16
    ds_write_b128 v8, v[68:71] offset:7360
    v_mov_b32 v60, 0
    v_mov_b32 v61, 0
    v_mov_b32 v62, 0
    v_mov_b32 v63, 0
    s_mov_b64 exec, 3
    v_subrev_u32 v9, 32, v8
    ds_write_b128 v9, v[60:63] offset:0
    ds_write_b128 v9, v[60:63] offset:2112
    ds_write_b128 v9, v[60:63] offset:4224
    ds_write_b128 v9, v[60:63] offset:6336
    s_mov_b64 exec, -1
    s_waitcnt lgkmcnt(14)
    v_cmp_gt_u32 vcc, 2, v39
    s_nop 0
    s_and_b32 s46, vcc_lo, 240
    s_cbranch_scc0 Lp_26
Lp_25:
    s_sleep 1
    ds_read_b32 v39, v79 offset:0
    s_waitcnt lgkmcnt(0)
    v_cmp_gt_u32 vcc, 2, v39
    s_nop 0
    s_and_b32 s46, vcc_lo, 240
    s_cbranch_scc1 Lp_25
Lp_26:
    ds_read_b64 v[128:129], v2 offset:0
    ds_read_b64 v[130:131], v2 offset:8
    ds_read_b64 v[160:161], v2 offset:512
    ds_read_b64 v[162:163], v2 offset:520
    ds_read_b64 v[192:193], v2 offset:1024
    ds_read_b64 v[194:195], v2 offset:1032
    ds_read_b64 v[224:225], v2 offset:1536
    ds_read_b64 v[226:227], v2 offset:1544
    ds_read_b128 v[40:43], v3 offset:3584
    ds_read_b64 v[132:133], v2 offset:64
    ds_read_b64 v[134:135], v2 offset:72
    ds_read_b64 v[164:165], v2 offset:576
    ds_read_b64 v[166:167], v2 offset:584
    ds_read_b64 v[196:197], v2 offset:1088
    ds_read_b64 v[198:199], v2 offset:1096
    ds_read_b64 v[228:229], v2 offset:1600
    ds_read_b64 v[230:231], v2 offset:1608
    ds_read_b128 v[44:47], v3 offset:3648
    ds_read_b64 v[136:137], v2 offset:128
    ds_read_b64 v[138:139], v2 offset:136
    ds_read_b64 v[168:169], v2 offset:640
    ds_read_b64 v[170:171], v2 offset:648
    ds_read_b64 v[200:201], v2 offset:1152
    ds_read_b64 v[202:203], v2 offset:1160
    ds_read_b64 v[232:233], v2 offset:1664
    ds_read_b64 v[234:235], v2 offset:1672
    ds_read_b128 v[48:51], v3 offset:3712
    ds_read_b64 v[140:141], v2 offset:192
    ds_read_b64 v[142:143], v2 offset:200
    ds_read_b64 v[172:173], v2 offset:704
    ds_read_b64 v[174:175], v2 offset:712
    ds_read_b64 v[204:205], v2 offset:1216
    ds_read_b64 v[206:207], v2 offset:1224
    ds_read_b64 v[236:237], v2 offset:1728
    ds_read_b64 v[238:239], v2 offset:1736
    ds_read_b128 v[52:55], v3 offset:3776
    ds_read_b64 v[144:145], v2 offset:256
    ds_read_b64 v[146:147], v2 offset:264
    ds_read_b64 v[176:177], v2 offset:768
    ds_read_b64 v[178:179], v2 offset:776
    ds_read_b64 v[208:209], v2 offset:1280
    ds_read_b64 v[210:211], v2 offset:1288
    ds_read_b64 v[240:241], v2 offset:1792
    ds_read_b64 v[242:243], v2 offset:1800
    ds_read_b128 v[56:59], v3 offset:3840
    ds_read_b64 v[148:149], v2 offset:320
    ds_read_b64 v[150:151], v2 offset:328
    ds_read_b64 v[180:181], v2 offset:832
    ds_read_b64 v[182:183], v2 offset:840
    ds_read_b64 v[212:213], v2 offset:1344
    ds_read_b64 v[214:215], v2 offset:1352
    ds_read_b64 v[244:245], v2 offset:1856
    ds_read_b64 v[246:247], v2 offset:1864
    ds_read_b128 v[60:63], v3 offset:3904
    ds_read_b64 v[152:153], v2 offset:384
    ds_read_b64 v[154:155], v2 offset:392
    ds_read_b64 v[184:185], v2 offset:896
    ds_read_b64 v[186:187], v2 offset:904
    ds_read_b64 v[216:217], v2 offset:1408
    ds_read_b64 v[218:219], v2 offset:1416
    ds_read_b64 v[248:249], v2 offset:1920
    ds_read_b64 v[250:251], v2 offset:1928
    ds_read_b128 v[64:67], v3 offset:3968
    s_waitcnt lgkmcnt(15)
    v_mfma_f32_16x16x32_bf16 v[96:99], v[128:131], v[40:43], 0
    ds_read_b128 v[68:71], v3 offset:4032
    ds_read_b64 v[156:157], v2 offset:448
    ds_read_b64 v[158:159], v2 offset:456
    v_mfma_f32_16x16x32_bf16 v[100:103], v[160:163], v[40:43], 0
    ds_read_b64 v[188:189], v2 offset:960
    ds_read_b64 v[190:191], v2 offset:968
    ds_read_b64 v[220:221], v2 offset:1472
    v_mfma_f32_16x16x32_bf16 v[104:107], v[192:195], v[40:43], 0
    ds_read_b64 v[222:223], v2 offset:1480
    ds_read_b64 v[252:253], v2 offset:1984
    ds_read_b64 v[254:255], v2 offset:1992
    v_mfma_f32_16x16x32_bf16 v[108:111], v[224:227], v[40:43], 0
    s_waitcnt lgkmcnt(15)
    v_mfma_f32_16x16x32_bf16 v[96:99], v[132:135], v[44:47], v[96:99]
    ds_read_b128 v[40:43], v3 offset:3072
    v_mfma_f32_16x16x32_bf16 v[100:103], v[164:167], v[44:47], v[100:103]
    v_mfma_f32_16x16x32_bf16 v[104:107], v[196:199], v[44:47], v[104:107]
    v_mfma_f32_16x16x32_bf16 v[108:111], v[228:231], v[44:47], v[108:111]
    s_waitcnt lgkmcnt(15)
    v_mfma_f32_16x16x32_bf16 v[96:99], v[136:139], v[48:51], v[96:99]
    ds_read_b128 v[44:47], v3 offset:3136
    v_mfma_f32_16x16x32_bf16 v[100:103], v[168:171], v[48:51], v[100:103]
    v_mfma_f32_16x16x32_bf16 v[104:107], v[200:203], v[48:51], v[104:107]
    v_mfma_f32_16x16x32_bf16 v[108:111], v[232:235], v[48:51], v[108:111]
    s_waitcnt lgkmcnt(15)
    v_mfma_f32_16x16x32_bf16 v[96:99], v[140:143], v[52:55], v[96:99]
    ds_read_b128 v[48:51], v3 offset:3200
    v_mfma_f32_16x16x32_bf16 v[100:103], v[172:175], v[52:55], v[100:103]
    v_mfma_f32_16x16x32_bf16 v[104:107], v[204:207], v[52:55], v[104:107]
    v_mfma_f32_16x16x32_bf16 v[108:111], v[236:239], v[52:55], v[108:111]
    s_waitcnt lgkmcnt(15)
    v_mfma_f32_16x16x32_bf16 v[96:99], v[144:147], v[56:59], v[96:99]
    ds_read_b128 v[52:55], v3 offset:3264
    v_mfma_f32_16x16x32_bf16 v[100:103], v[176:179], v[56:59], v[100:103]
    v_mfma_f32_16x16x32_bf16 v[104:107], v[208:211], v[56:59], v[104:107]
    v_mfma_f32_16x16x32_bf16 v[108:111], v[240:243], v[56:59], v[108:111]
    s_waitcnt lgkmcnt(15)
    v_mfma_f32_16x16x32_bf16 v[96:99], v[148:151], v[60:63], v[96:99]
    ds_read_b128 v[56:59], v3 offset:3328
    v_mfma_f32_16x16x32_bf16 v[100:103], v[180:183], v[60:63], v[100:103]
    v_mfma_f32_16x16x32_bf16 v[104:107], v[212:215], v[60:63], v[104:107]
    v_mfma_f32_16x16x32_bf16 v[108:111], v[244:247], v[60:63], v[108:111]
    s_waitcnt lgkmcnt(14)
    v_mfma_f32_16x16x32_bf16 v[96:99], v[152:155], v[64:67], v[96:99]
    ds_read_b128 v[60:63], v3 offset:3392
    v_mfma_f32_16x16x32_bf16 v[100:103], v[184:187], v[64:67], v[100:103]
    v_mfma_f32_16x16x32_bf16 v[104:107], v[216:219], v[64:67], v[104:107]
    v_mfma_f32_16x16x32_bf16 v[108:111], v[248:251], v[64:67], v[108:111]
    s_waitcnt lgkmcnt(12)
    v_mfma_f32_16x16x32_bf16 v[96:99], v[156:159], v[68:71], v[96:99]
    ds_read_b128 v[64:67], v3 offset:3456
    s_waitcnt lgkmcnt(11)
    v_mfma_f32_16x16x32_bf16 v[100:103], v[188:191], v[68:71], v[100:103]
    s_waitcnt lgkmcnt(9)
    v_mfma_f32_16x16x32_bf16 v[104:107], v[220:223], v[68:71], v[104:107]
    s_waitcnt lgkmcnt(7)
    v_mfma_f32_16x16x32_bf16 v[108:111], v[252:255], v[68:71], v[108:111]
    ds_read_u16 v14, v6 offset:0
    ds_read_u16 v15, v6 offset:2
    ds_read_u16 v16, v6 offset:4
    s_waitcnt lgkmcnt(9)
    v_mfma_f32_16x16x32_bf16 v[100:103], v[128:131], v[40:43], v[100:103]
    ds_read_b128 v[68:71], v3 offset:3520
    v_mfma_f32_16x16x32_bf16 v[104:107], v[160:163], v[40:43], v[104:107]
    ds_read_u16 v17, v6 offset:6
    v_mfma_f32_16x16x32_bf16 v[108:111], v[192:195], v[40:43], v[108:111]
    ds_read_u16 v18, v6 offset:8
    v_cvt_pk_bf16_f32 v12, v96, v97
    v_cvt_pk_bf16_f32 v13, v98, v99
    v_mfma_f32_16x16x32_bf16 v[112:115], v[224:227], v[40:43], 0
    ds_read_u16 v19, v6 offset:10
    ds_write_b64 v5, v[12:13] offset:0
    v_mov_b32 v10, 2
    s_waitcnt lgkmcnt(13)
    v_mfma_f32_16x16x32_bf16 v[100:103], v[132:135], v[44:47], v[100:103]
    ds_read_b128 v[40:43], v3 offset:2560
    ds_write_b32 v0, v10
    v_mfma_f32_16x16x32_bf16 v[104:107], v[164:167], v[44:47], v[104:107]
    ds_read_u16 v36, v6 offset:12
    v_mfma_f32_16x16x32_bf16 v[108:111], v[196:199], v[44:47], v[108:111]
    ds_read_u16 v37, v6 offset:14
    v_mfma_f32_16x16x32_bf16 v[112:115], v[228:231], v[44:47], v[112:115]
    s_waitcnt lgkmcnt(15)
    v_mfma_f32_16x16x32_bf16 v[100:103], v[136:139], v[48:51], v[100:103]
    ds_read_b128 v[44:47], v3 offset:2624
    v_mfma_f32_16x16x32_bf16 v[104:107], v[168:171], v[48:51], v[104:107]
    v_mfma_f32_16x16x32_bf16 v[108:111], v[200:203], v[48:51], v[108:111]
    v_mfma_f32_16x16x32_bf16 v[112:115], v[232:235], v[48:51], v[112:115]
    s_waitcnt lgkmcnt(15)
    v_mfma_f32_16x16x32_bf16 v[100:103], v[140:143], v[52:55], v[100:103]
    ds_read_b128 v[48:51], v3 offset:2688
    s_waitcnt lgkmcnt(12)
    v_lshl_or_b32 v72, v15, 16, v14
    v_mfma_f32_16x16x32_bf16 v[104:107], v[172:175], v[52:55], v[104:107]
    s_waitcnt lgkmcnt(9)
    v_lshl_or_b32 v73, v17, 16, v16
    s_waitcnt lgkmcnt(7)
    v_lshl_or_b32 v74, v19, 16, v18
    v_mfma_f32_16x16x32_bf16 v[108:111], v[204:207], v[52:55], v[108:111]
    s_waitcnt lgkmcnt(2)
    v_lshl_or_b32 v75, v37, 16, v36
    v_mfma_f32_16x16x32_bf16 v[112:115], v[236:239], v[52:55], v[112:115]
    ds_read_b128 v[20:23], v3 offset:3584
    v_mfma_f32_16x16x32_bf16 v[100:103], v[144:147], v[56:59], v[100:103]
    ds_read_b128 v[52:55], v3 offset:2752
    v_mfma_f32_16x16x32_bf16 v[104:107], v[176:179], v[56:59], v[104:107]
    ds_read_b128 v[24:27], v3 offset:3072
    v_mfma_f32_16x16x32_bf16 v[108:111], v[208:211], v[56:59], v[108:111]
    ds_read_b128 v[28:31], v3 offset:2560
    v_mfma_f32_16x16x32_bf16 v[112:115], v[240:243], v[56:59], v[112:115]
    ds_read_b128 v[32:35], v3 offset:2048
    v_mfma_f32_16x16x32_bf16 v[100:103], v[148:151], v[60:63], v[100:103]
    ds_read_b128 v[56:59], v3 offset:2816
    v_mfma_f32_16x16x32_bf16 v[104:107], v[180:183], v[60:63], v[104:107]
    ds_read_u16 v14, v4 offset:112
    v_mfma_f32_16x16x32_bf16 v[108:111], v[212:215], v[60:63], v[108:111]
    ds_read_u16 v15, v4 offset:96
    v_mfma_f32_16x16x32_bf16 v[112:115], v[244:247], v[60:63], v[112:115]
    ds_read_u16 v16, v4 offset:80
    v_mfma_f32_16x16x32_bf16 v[100:103], v[152:155], v[64:67], v[100:103]
    ds_read_b128 v[60:63], v3 offset:2880
    v_mfma_f32_16x16x32_bf16 v[104:107], v[184:187], v[64:67], v[104:107]
    ds_read_u16 v17, v4 offset:64
    v_mfma_f32_16x16x32_bf16 v[108:111], v[216:219], v[64:67], v[108:111]
    ds_read_u16 v18, v4 offset:48
    v_mfma_f32_16x16x32_bf16 v[112:115], v[248:251], v[64:67], v[112:115]
    ds_read_u16 v19, v4 offset:32
    v_mfma_f32_16x16x32_bf16 v[100:103], v[156:159], v[68:71], v[100:103]
    ds_read_b128 v[64:67], v3 offset:2944
    v_mfma_f32_16x16x32_bf16 v[104:107], v[188:191], v[68:71], v[104:107]
    ds_read_u16 v36, v4 offset:16
    v_mfma_f32_16x16x32_bf16 v[108:111], v[220:223], v[68:71], v[108:111]
    ds_read_u16 v37, v4 offset:0
    v_mfma_f32_16x16x32_bf16 v[112:115], v[252:255], v[68:71], v[112:115]
    v_mfma_f32_16x16x32_bf16 v[104:107], v[128:131], v[40:43], v[104:107]
    ds_read_b128 v[68:71], v3 offset:3008
    v_mfma_f32_16x16x32_bf16 v[108:111], v[160:163], v[40:43], v[108:111]
    v_mfma_f32_16x16x32_bf16 v[112:115], v[192:195], v[40:43], v[112:115]
    v_cvt_pk_bf16_f32 v12, v100, v101
    v_cvt_pk_bf16_f32 v13, v102, v103
    v_mfma_f32_16x16x32_bf16 v[116:119], v[224:227], v[40:43], 0
    ds_write_b64 v5, v[12:13] offset:2304
    v_mov_b32 v10, 3
    s_waitcnt lgkmcnt(15)
    v_mfma_f32_16x16x32_bf16 v[104:107], v[132:135], v[44:47], v[104:107]
    ds_read_b128 v[40:43], v3 offset:2048
    s_waitcnt lgkmcnt(11)
    v_lshl_or_b32 v80, v15, 16, v14
    ds_write_b32 v0, v10
    v_mfma_f32_16x16x32_bf16 v[108:111], v[164:167], v[44:47], v[108:111]
    s_waitcnt lgkmcnt(9)
    v_lshl_or_b32 v81, v17, 16, v16
    s_waitcnt lgkmcnt(7)
    v_lshl_or_b32 v82, v19, 16, v18
    v_mfma_f32_16x16x32_bf16 v[112:115], v[196:199], v[44:47], v[112:115]
    s_waitcnt lgkmcnt(4)
    v_lshl_or_b32 v83, v37, 16, v36
    v_mfma_f32_16x16x32_bf16 v[116:119], v[228:231], v[44:47], v[116:119]
    ds_read_u16 v14, v4 offset:624
    v_mfma_f32_16x16x32_bf16 v[104:107], v[136:139], v[48:51], v[104:107]
    ds_read_b128 v[44:47], v3 offset:2112
    v_mfma_f32_16x16x32_bf16 v[108:111], v[168:171], v[48:51], v[108:111]
    ds_read_u16 v15, v4 offset:608
    v_mfma_f32_16x16x32_bf16 v[112:115], v[200:203], v[48:51], v[112:115]
    ds_read_u16 v16, v4 offset:592
    v_mfma_f32_16x16x32_bf16 v[116:119], v[232:235], v[48:51], v[116:119]
    ds_read_u16 v17, v4 offset:576
    v_mfma_f32_16x16x32_bf16 v[104:107], v[140:143], v[52:55], v[104:107]
    ds_read_b128 v[48:51], v3 offset:2176
    v_mfma_f32_16x16x32_bf16 v[108:111], v[172:175], v[52:55], v[108:111]
    ds_read_u16 v18, v4 offset:560
    v_mfma_f32_16x16x32_bf16 v[112:115], v[204:207], v[52:55], v[112:115]
    ds_read_u16 v19, v4 offset:544
    v_mfma_f32_16x16x32_bf16 v[116:119], v[236:239], v[52:55], v[116:119]
    ds_read_u16 v36, v4 offset:528
    v_mfma_f32_16x16x32_bf16 v[112:115], v[72:75], v[20:23], v[112:115]
    ds_read_u16 v37, v4 offset:512
    v_mfma_f32_16x16x32_bf16 v[116:119], v[72:75], v[24:27], v[116:119]
    v_mfma_f32_16x16x32_bf16 v[120:123], v[72:75], v[28:31], 0
    v_mfma_f32_16x16x32_bf16 v[124:127], v[72:75], v[32:35], 0
    v_mfma_f32_16x16x32_bf16 v[104:107], v[144:147], v[56:59], v[104:107]
    ds_read_b128 v[52:55], v3 offset:2240
    v_mfma_f32_16x16x32_bf16 v[108:111], v[176:179], v[56:59], v[108:111]
    v_mfma_f32_16x16x32_bf16 v[112:115], v[208:211], v[56:59], v[112:115]
    s_waitcnt lgkmcnt(8)
    v_lshl_or_b32 v84, v15, 16, v14
    s_waitcnt lgkmcnt(6)
    v_lshl_or_b32 v85, v17, 16, v16
    v_mfma_f32_16x16x32_bf16 v[116:119], v[240:243], v[56:59], v[116:119]
    s_waitcnt lgkmcnt(3)
    v_lshl_or_b32 v86, v19, 16, v18
    s_waitcnt lgkmcnt(1)
    v_lshl_or_b32 v87, v37, 16, v36
    v_mfma_f32_16x16x32_bf16 v[104:107], v[148:151], v[60:63], v[104:107]
    ds_read_b128 v[56:59], v3 offset:2304
    v_mfma_f32_16x16x32_bf16 v[108:111], v[180:183], v[60:63], v[108:111]
    ds_read_u16 v14, v4 offset:1136
    v_mfma_f32_16x16x32_bf16 v[112:115], v[212:215], v[60:63], v[112:115]
    ds_read_u16 v15, v4 offset:1120
    v_mfma_f32_16x16x32_bf16 v[116:119], v[244:247], v[60:63], v[116:119]
    ds_read_u16 v16, v4 offset:1104
    v_mfma_f32_16x16x32_bf16 v[104:107], v[152:155], v[64:67], v[104:107]
    ds_read_b128 v[60:63], v3 offset:2368
    v_mfma_f32_16x16x32_bf16 v[108:111], v[184:187], v[64:67], v[108:111]
    ds_read_u16 v17, v4 offset:1088
    v_mfma_f32_16x16x32_bf16 v[112:115], v[216:219], v[64:67], v[112:115]
    ds_read_u16 v18, v4 offset:1072
    v_mfma_f32_16x16x32_bf16 v[116:119], v[248:251], v[64:67], v[116:119]
    ds_read_u16 v19, v4 offset:1056
    ds_read_b32 v39, v79 offset:0
    v_mfma_f32_16x16x32_bf16 v[104:107], v[156:159], v[68:71], v[104:107]
    ds_read_b128 v[64:67], v3 offset:2432
    v_mfma_f32_16x16x32_bf16 v[108:111], v[188:191], v[68:71], v[108:111]
    ds_read_u16 v36, v4 offset:1040
    v_mfma_f32_16x16x32_bf16 v[112:115], v[220:223], v[68:71], v[112:115]
    ds_read_u16 v37, v4 offset:1024
    v_mfma_f32_16x16x32_bf16 v[116:119], v[252:255], v[68:71], v[116:119]
    s_waitcnt lgkmcnt(3)
    v_cmp_gt_u32 vcc, 3, v39
    s_nop 0
    s_and_b32 s46, vcc_lo, 240
    s_cbranch_scc0 Lp_28
Lp_27:
    s_sleep 1
    ds_read_b32 v39, v79 offset:0
    s_waitcnt lgkmcnt(0)
    v_cmp_gt_u32 vcc, 3, v39
    s_nop 0
    s_and_b32 s46, vcc_lo, 240
    s_cbranch_scc1 Lp_27
Lp_28:
    v_mfma_f32_16x16x32_bf16 v[108:111], v[128:131], v[40:43], v[108:111]
    ds_read_b128 v[68:71], v3 offset:2496
    v_mfma_f32_16x16x32_bf16 v[112:115], v[160:163], v[40:43], v[112:115]
    ds_read_b128 v[20:23], v7 offset:0
    v_mfma_f32_16x16x32_bf16 v[116:119], v[192:195], v[40:43], v[116:119]
    ds_read_b128 v[24:27], v7 offset:64
    v_cvt_pk_bf16_f32 v12, v104, v105
    v_cvt_pk_bf16_f32 v13, v106, v107
    v_mfma_f32_16x16x32_bf16 v[120:123], v[224:227], v[40:43], v[120:123]
    ds_read_b128 v[28:31], v7 offset:128
    ds_write_b64 v5, v[12:13] offset:4608
    v_mov_b32 v10, 4
    v_mfma_f32_16x16x32_bf16 v[108:111], v[132:135], v[44:47], v[108:111]
    ds_read_b128 v[40:43], v3 offset:1536
    v_lshl_or_b32 v88, v15, 16, v14
    ds_write_b32 v0, v10
    v_mfma_f32_16x16x32_bf16 v[112:115], v[164:167], v[44:47], v[112:115]
    ds_read_b128 v[32:35], v7 offset:192
    v_lshl_or_b32 v89, v17, 16, v16
    v_lshl_or_b32 v90, v19, 16, v18
    v_mfma_f32_16x16x32_bf16 v[116:119], v[196:199], v[44:47], v[116:119]
    s_waitcnt lgkmcnt(8)
    v_lshl_or_b32 v91, v37, 16, v36
    v_mfma_f32_16x16x32_bf16 v[120:123], v[228:231], v[44:47], v[120:123]
    ds_read_u16 v14, v4 offset:1648
    v_mfma_f32_16x16x32_bf16 v[108:111], v[136:139], v[48:51], v[108:111]
    ds_read_b128 v[44:47], v3 offset:1600
    v_mfma_f32_16x16x32_bf16 v[112:115], v[168:171], v[48:51], v[112:115]
    ds_read_u16 v15, v4 offset:1632
    v_mfma_f32_16x16x32_bf16 v[116:119], v[200:203], v[48:51], v[116:119]
    ds_read_u16 v16, v4 offset:1616
    v_mfma_f32_16x16x32_bf16 v[120:123], v[232:235], v[48:51], v[120:123]
    ds_read_u16 v17, v4 offset:1600
    v_mfma_f32_16x16x32_bf16 v[108:111], v[140:143], v[52:55], v[108:111]
    ds_read_b128 v[48:51], v3 offset:1664
    v_mfma_f32_16x16x32_bf16 v[112:115], v[172:175], v[52:55], v[112:115]
    ds_read_u16 v18, v4 offset:1584
    v_mfma_f32_16x16x32_bf16 v[116:119], v[204:207], v[52:55], v[116:119]
    ds_read_u16 v19, v4 offset:1568
    v_mfma_f32_16x16x32_bf16 v[120:123], v[236:239], v[52:55], v[120:123]
    ds_read_u16 v36, v4 offset:1552
    v_mfma_f32_16x16x32_bf16 v[108:111], v[144:147], v[56:59], v[108:111]
    ds_read_b128 v[52:55], v3 offset:1728
    v_mfma_f32_16x16x32_bf16 v[112:115], v[176:179], v[56:59], v[112:115]
    ds_read_u16 v37, v4 offset:1536
    v_mfma_f32_16x16x32_bf16 v[116:119], v[208:211], v[56:59], v[116:119]
    v_mfma_f32_16x16x32_bf16 v[120:123], v[240:243], v[56:59], v[120:123]
    v_mfma_f32_16x16x32_bf16 v[108:111], v[148:151], v[60:63], v[108:111]
    ds_read_b128 v[56:59], v3 offset:1792
    v_mfma_f32_16x16x32_bf16 v[112:115], v[180:183], v[60:63], v[112:115]
    v_mfma_f32_16x16x32_bf16 v[116:119], v[212:215], v[60:63], v[116:119]
    v_mfma_f32_16x16x32_bf16 v[120:123], v[244:247], v[60:63], v[120:123]
    s_waitcnt lgkmcnt(9)
    v_lshl_or_b32 v92, v15, 16, v14
    s_waitcnt lgkmcnt(7)
    v_lshl_or_b32 v93, v17, 16, v16
    v_mfma_f32_16x16x32_bf16 v[108:111], v[152:155], v[64:67], v[108:111]
    ds_read_b128 v[60:63], v3 offset:1856
    s_waitcnt lgkmcnt(5)
    v_lshl_or_b32 v94, v19, 16, v18
    v_mfma_f32_16x16x32_bf16 v[112:115], v[184:187], v[64:67], v[112:115]
    s_waitcnt lgkmcnt(2)
    v_lshl_or_b32 v95, v37, 16, v36
    v_mfma_f32_16x16x32_bf16 v[116:119], v[216:219], v[64:67], v[116:119]
    v_mfma_f32_16x16x32_bf16 v[120:123], v[248:251], v[64:67], v[120:123]
    v_mfma_f32_16x16x32_bf16 v[108:111], v[156:159], v[68:71], v[108:111]
    ds_read_b128 v[64:67], v3 offset:1920
    v_mfma_f32_16x16x32_bf16 v[112:115], v[188:191], v[68:71], v[112:115]
    v_mfma_f32_16x16x32_bf16 v[116:119], v[220:223], v[68:71], v[116:119]
    v_mfma_f32_16x16x32_bf16 v[120:123], v[252:255], v[68:71], v[120:123]
    v_mfma_f32_16x16x32_bf16 v[112:115], v[128:131], v[40:43], v[112:115]
    ds_read_b128 v[68:71], v3 offset:1984
    v_mfma_f32_16x16x32_bf16 v[116:119], v[160:163], v[40:43], v[116:119]
    v_mfma_f32_16x16x32_bf16 v[120:123], v[192:195], v[40:43], v[120:123]
    v_cvt_pk_bf16_f32 v12, v108, v109
    v_cvt_pk_bf16_f32 v13, v110, v111
    v_mfma_f32_16x16x32_bf16 v[124:127], v[224:227], v[40:43], v[124:127]
    ds_write_b64 v5, v[12:13] offset:6912
    v_mov_b32 v10, 5
    v_mfma_f32_16x16x32_bf16 v[112:115], v[132:135], v[44:47], v[112:115]
    ds_read_b128 v[40:43], v3 offset:1024
    ds_write_b32 v0, v10
    v_mfma_f32_16x16x32_bf16 v[116:119], v[164:167], v[44:47], v[116:119]
    v_mfma_f32_16x16x32_bf16 v[120:123], v[196:199], v[44:47], v[120:123]
    v_mfma_f32_16x16x32_bf16 v[124:127], v[228:231], v[44:47], v[124:127]
    v_mfma_f32_16x16x32_bf16 v[112:115], v[20:23], v[80:83], v[112:115]
    v_mfma_f32_16x16x32_bf16 v[116:119], v[20:23], v[84:87], v[116:119]
    v_mfma_f32_16x16x32_bf16 v[120:123], v[20:23], v[88:91], v[120:123]
    v_mfma_f32_16x16x32_bf16 v[124:127], v[20:23], v[92:95], v[124:127]
    v_mfma_f32_16x16x32_bf16 v[116:119], v[24:27], v[80:83], v[116:119]
    v_mfma_f32_16x16x32_bf16 v[120:123], v[24:27], v[84:87], v[120:123]
    v_mfma_f32_16x16x32_bf16 v[124:127], v[24:27], v[88:91], v[124:127]
    v_mfma_f32_16x16x32_bf16 v[120:123], v[28:31], v[80:83], v[120:123]
    v_mfma_f32_16x16x32_bf16 v[124:127], v[28:31], v[84:87], v[124:127]
    v_mfma_f32_16x16x32_bf16 v[124:127], v[32:35], v[80:83], v[124:127]
    v_mfma_f32_16x16x32_bf16 v[112:115], v[136:139], v[48:51], v[112:115]
    ds_read_b128 v[44:47], v3 offset:1088
    v_mfma_f32_16x16x32_bf16 v[116:119], v[168:171], v[48:51], v[116:119]
    v_mfma_f32_16x16x32_bf16 v[120:123], v[200:203], v[48:51], v[120:123]
    v_mfma_f32_16x16x32_bf16 v[124:127], v[232:235], v[48:51], v[124:127]
    v_mfma_f32_16x16x32_bf16 v[112:115], v[140:143], v[52:55], v[112:115]
    ds_read_b128 v[48:51], v3 offset:1152
    v_mfma_f32_16x16x32_bf16 v[116:119], v[172:175], v[52:55], v[116:119]
    v_mfma_f32_16x16x32_bf16 v[120:123], v[204:207], v[52:55], v[120:123]
    v_mfma_f32_16x16x32_bf16 v[124:127], v[236:239], v[52:55], v[124:127]
    s_waitcnt lgkmcnt(8)
    v_mfma_f32_16x16x32_bf16 v[112:115], v[144:147], v[56:59], v[112:115]
    ds_read_b128 v[52:55], v3 offset:1216
    v_mfma_f32_16x16x32_bf16 v[116:119], v[176:179], v[56:59], v[116:119]
    v_mfma_f32_16x16x32_bf16 v[120:123], v[208:211], v[56:59], v[120:123]
    v_mfma_f32_16x16x32_bf16 v[124:127], v[240:243], v[56:59], v[124:127]
    s_waitcnt lgkmcnt(8)
    v_mfma_f32_16x16x32_bf16 v[112:115], v[148:151], v[60:63], v[112:115]
    ds_read_b128 v[56:59], v3 offset:1280
    v_mfma_f32_16x16x32_bf16 v[116:119], v[180:183], v[60:63], v[116:119]
    v_mfma_f32_16x16x32_bf16 v[120:123], v[212:215], v[60:63], v[120:123]
    v_mfma_f32_16x16x32_bf16 v[124:127], v[244:247], v[60:63], v[124:127]
    s_waitcnt lgkmcnt(8)
    v_mfma_f32_16x16x32_bf16 v[112:115], v[152:155], v[64:67], v[112:115]
    ds_read_b128 v[60:63], v3 offset:1344
    v_mfma_f32_16x16x32_bf16 v[116:119], v[184:187], v[64:67], v[116:119]
    v_mfma_f32_16x16x32_bf16 v[120:123], v[216:219], v[64:67], v[120:123]
    v_mfma_f32_16x16x32_bf16 v[124:127], v[248:251], v[64:67], v[124:127]
    s_waitcnt lgkmcnt(8)
    v_mfma_f32_16x16x32_bf16 v[112:115], v[156:159], v[68:71], v[112:115]
    ds_read_b128 v[64:67], v3 offset:1408
    v_mfma_f32_16x16x32_bf16 v[116:119], v[188:191], v[68:71], v[116:119]
    v_mfma_f32_16x16x32_bf16 v[120:123], v[220:223], v[68:71], v[120:123]
    v_mfma_f32_16x16x32_bf16 v[124:127], v[252:255], v[68:71], v[124:127]
    s_waitcnt lgkmcnt(7)
    v_mfma_f32_16x16x32_bf16 v[116:119], v[128:131], v[40:43], v[116:119]
    ds_read_b128 v[68:71], v3 offset:1472
    v_mfma_f32_16x16x32_bf16 v[120:123], v[160:163], v[40:43], v[120:123]
    v_mfma_f32_16x16x32_bf16 v[124:127], v[192:195], v[40:43], v[124:127]
    v_cvt_pk_bf16_f32 v12, v112, v113
    v_cvt_pk_bf16_f32 v13, v114, v115
    s_waitcnt lgkmcnt(6)
    v_mfma_f32_16x16x32_bf16 v[116:119], v[132:135], v[44:47], v[116:119]
    ds_read_b128 v[40:43], v3 offset:512
    ds_write_b64 v5, v[12:13] offset:9216
    v_mov_b32 v10, 6
    v_mfma_f32_16x16x32_bf16 v[120:123], v[164:167], v[44:47], v[120:123]
    ds_write_b32 v0, v10
    v_mfma_f32_16x16x32_bf16 v[124:127], v[196:199], v[44:47], v[124:127]
    s_waitcnt lgkmcnt(8)
    v_mfma_f32_16x16x32_bf16 v[116:119], v[136:139], v[48:51], v[116:119]
    ds_read_b128 v[44:47], v3 offset:576
    v_mfma_f32_16x16x32_bf16 v[120:123], v[168:171], v[48:51], v[120:123]
    v_mfma_f32_16x16x32_bf16 v[124:127], v[200:203], v[48:51], v[124:127]
    s_waitcnt lgkmcnt(8)
    v_mfma_f32_16x16x32_bf16 v[116:119], v[140:143], v[52:55], v[116:119]
    ds_read_b128 v[48:51], v3 offset:640
    v_mfma_f32_16x16x32_bf16 v[120:123], v[172:175], v[52:55], v[120:123]
    v_mfma_f32_16x16x32_bf16 v[124:127], v[204:207], v[52:55], v[124:127]
    s_waitcnt lgkmcnt(8)
    v_mfma_f32_16x16x32_bf16 v[116:119], v[144:147], v[56:59], v[116:119]
    ds_read_b128 v[52:55], v3 offset:704
    v_mfma_f32_16x16x32_bf16 v[120:123], v[176:179], v[56:59], v[120:123]
    v_mfma_f32_16x16x32_bf16 v[124:127], v[208:211], v[56:59], v[124:127]
    s_waitcnt lgkmcnt(8)
    v_mfma_f32_16x16x32_bf16 v[116:119], v[148:151], v[60:63], v[116:119]
    ds_read_b128 v[56:59], v3 offset:768
    v_mfma_f32_16x16x32_bf16 v[120:123], v[180:183], v[60:63], v[120:123]
    v_mfma_f32_16x16x32_bf16 v[124:127], v[212:215], v[60:63], v[124:127]
    s_waitcnt lgkmcnt(8)
    v_mfma_f32_16x16x32_bf16 v[116:119], v[152:155], v[64:67], v[116:119]
    ds_read_b128 v[60:63], v3 offset:832
    v_mfma_f32_16x16x32_bf16 v[120:123], v[184:187], v[64:67], v[120:123]
    v_mfma_f32_16x16x32_bf16 v[124:127], v[216:219], v[64:67], v[124:127]
    s_waitcnt lgkmcnt(8)
    v_mfma_f32_16x16x32_bf16 v[116:119], v[156:159], v[68:71], v[116:119]
    ds_read_b128 v[64:67], v3 offset:896
    v_mfma_f32_16x16x32_bf16 v[120:123], v[188:191], v[68:71], v[120:123]
    v_mfma_f32_16x16x32_bf16 v[124:127], v[220:223], v[68:71], v[124:127]
    s_waitcnt lgkmcnt(8)
    v_mfma_f32_16x16x32_bf16 v[120:123], v[128:131], v[40:43], v[120:123]
    ds_read_b128 v[68:71], v3 offset:960
    v_mfma_f32_16x16x32_bf16 v[124:127], v[160:163], v[40:43], v[124:127]
    s_waitcnt lgkmcnt(6)
    v_mfma_f32_16x16x32_bf16 v[120:123], v[132:135], v[44:47], v[120:123]
    ds_read_b128 v[40:43], v3 offset:0
    v_cvt_pk_bf16_f32 v12, v116, v117
    v_cvt_pk_bf16_f32 v13, v118, v119
    v_mfma_f32_16x16x32_bf16 v[124:127], v[164:167], v[44:47], v[124:127]
    ds_write_b64 v5, v[12:13] offset:11520
    v_mov_b32 v10, 7
    s_waitcnt lgkmcnt(7)
    v_mfma_f32_16x16x32_bf16 v[120:123], v[136:139], v[48:51], v[120:123]
    ds_read_b128 v[44:47], v3 offset:64
    ds_write_b32 v0, v10
    v_mfma_f32_16x16x32_bf16 v[124:127], v[168:171], v[48:51], v[124:127]
    s_waitcnt lgkmcnt(8)
    v_mfma_f32_16x16x32_bf16 v[120:123], v[140:143], v[52:55], v[120:123]
    ds_read_b128 v[48:51], v3 offset:128
    v_mfma_f32_16x16x32_bf16 v[124:127], v[172:175], v[52:55], v[124:127]
    s_waitcnt lgkmcnt(8)
    v_mfma_f32_16x16x32_bf16 v[120:123], v[144:147], v[56:59], v[120:123]
    ds_read_b128 v[52:55], v3 offset:192
    v_mfma_f32_16x16x32_bf16 v[124:127], v[176:179], v[56:59], v[124:127]
    s_waitcnt lgkmcnt(8)
    v_mfma_f32_16x16x32_bf16 v[120:123], v[148:151], v[60:63], v[120:123]
    ds_read_b128 v[56:59], v3 offset:256
    v_mfma_f32_16x16x32_bf16 v[124:127], v[180:183], v[60:63], v[124:127]
    s_waitcnt lgkmcnt(8)
    v_mfma_f32_16x16x32_bf16 v[120:123], v[152:155], v[64:67], v[120:123]
    ds_read_b128 v[60:63], v3 offset:320
    v_mfma_f32_16x16x32_bf16 v[124:127], v[184:187], v[64:67], v[124:127]
    s_waitcnt lgkmcnt(8)
    v_mfma_f32_16x16x32_bf16 v[120:123], v[156:159], v[68:71], v[120:123]
    ds_read_b128 v[64:67], v3 offset:384
    v_mfma_f32_16x16x32_bf16 v[124:127], v[188:191], v[68:71], v[124:127]
    s_waitcnt lgkmcnt(8)
    v_mfma_f32_16x16x32_bf16 v[124:127], v[128:131], v[40:43], v[124:127]
    ds_read_b128 v[68:71], v3 offset:448
    s_waitcnt lgkmcnt(7)
    v_mfma_f32_16x16x32_bf16 v[124:127], v[132:135], v[44:47], v[124:127]
    s_waitcnt lgkmcnt(5)
    v_mfma_f32_16x16x32_bf16 v[124:127], v[136:139], v[48:51], v[124:127]
    v_cvt_pk_bf16_f32 v12, v120, v121
    v_cvt_pk_bf16_f32 v13, v122, v123
    s_waitcnt lgkmcnt(4)
    v_mfma_f32_16x16x32_bf16 v[124:127], v[140:143], v[52:55], v[124:127]
    ds_write_b64 v5, v[12:13] offset:13824
    v_mov_b32 v10, 8
    s_waitcnt lgkmcnt(4)
    v_mfma_f32_16x16x32_bf16 v[124:127], v[144:147], v[56:59], v[124:127]
    ds_write_b32 v0, v10
    s_waitcnt lgkmcnt(4)
    v_mfma_f32_16x16x32_bf16 v[124:127], v[148:151], v[60:63], v[124:127]
    s_waitcnt lgkmcnt(3)
    v_mfma_f32_16x16x32_bf16 v[124:127], v[152:155], v[64:67], v[124:127]
    s_waitcnt lgkmcnt(2)
    v_mfma_f32_16x16x32_bf16 v[124:127], v[156:159], v[68:71], v[124:127]
    s_nop 7
    v_cvt_pk_bf16_f32 v12, v124, v125
    v_cvt_pk_bf16_f32 v13, v126, v127
    ds_write_b64 v5, v[12:13] offset:16128
    v_mov_b32 v10, 9
    ds_write_b32 v0, v10
    s_branch L_fin
L_BH:
    s_nop 4
    ds_write_b128 v12, v[96:99] offset:9216
    ds_write_b128 v12, v[100:103] offset:10240
    ds_write_b128 v12, v[104:107] offset:11264
    v_mov_b32 v39, 1
    ds_write_b32 v0, v39 offset:0
    global_load_dwordx2 v[118:119], v2, s[16:17] offset:3840
    v_add_u32 v3, 1310720, v2
    v_lshlrev_b32 v15, 3, v16
    v_sub_u32 v4, 2040, v15
    v_mul_u32_u24 v7, 2560, v16
    s_add_u32 s47, s55, 1280
    v_add_u32 v7, s47, v7
    v_bfe_u32 v13, v1, 2, 2
    v_mul_u32_u24 v13, 576, v13
    v_and_b32 v14, 3, v1
    v_lshl_add_u32 v13, v14, 3, v13
    v_lshl_add_u32 v13, v11, 5, v13
    s_lshl_b32 s47, s57, 7
    s_add_u32 s47, s47, 125888
    v_add_u32 v6, s47, v13
    s_mov_b32 s48, 0x05040100
    s_mov_b32 s49, 0x07060302
    s_waitcnt vmcnt(0)
    v_perm_b32 v40, v116, v118, s48
    v_perm_b32 v41, v112, v114, s48
    ds_write_b64 v4, v[40:41] offset:2048
    v_perm_b32 v42, v116, v118, s49
    v_perm_b32 v43, v112, v114, s49
    ds_write_b64 v4, v[42:43] offset:15088
    v_perm_b32 v44, v117, v119, s48
    v_perm_b32 v45, v113, v115, s48
    ds_write_b64 v4, v[44:45] offset:28128
    v_perm_b32 v46, v117, v119, s49
    v_perm_b32 v47, v113, v115, s49
    ds_write_b64 v4, v[46:47] offset:41168
    v_mov_b32 v12, 0
    v_mov_b32 v13, 0
    v_mov_b32 v14, 0
    v_mov_b32 v15, 0
    v_lshlrev_b32 v16, 4, v1
    v_add_u32 v16, s44, v16
    s_mov_b64 exec, 0x3fffffff
    ds_write_b128 v16, v[12:15] offset:4096
    s_mov_b64 exec, -1
    v_mov_b32 v39, 2
    ds_write_b32 v0, v39 offset:0
    global_load_dwordx2 v[120:121], v3, s[16:17] offset:0
    global_load_dwordx2 v[122:123], v3, s[16:17] offset:1280
    global_load_dwordx2 v[124:125], v3, s[16:17] offset:2560
    global_load_dwordx2 v[126:127], v3, s[16:17] offset:3840
    v_lshlrev_b32 v12, 5, v1
    s_add_u32 s47, s44, 4064
    v_sub_u32 v12, s47, v12
    ds_read_b32 v39, v79 offset:0
    s_waitcnt lgkmcnt(0)
    v_cmp_gt_u32 vcc, 2, v39
    s_nop 0
    s_and_b32 s46, vcc_lo, 240
    s_cbranch_scc0 Lp_30
Lp_29:
    s_sleep 1
    ds_read_b32 v39, v79 offset:0
    s_waitcnt lgkmcnt(0)
    v_cmp_gt_u32 vcc, 2, v39
    s_nop 0
    s_and_b32 s46, vcc_lo, 240
    s_cbranch_scc1 Lp_29
Lp_30:
    s_setprio 2
    ds_read_b128 v[48:51], v12 offset:0
    ds_read_b128 v[52:55], v12 offset:16
    ds_read_b128 v[56:59], v12 offset:32
    ds_read_b128 v[60:63], v12 offset:48
    ds_read_b128 v[64:67], v12 offset:64
    s_waitcnt lgkmcnt(0)
    v_and_b32 v128, 0xffff0000, v65
    v_lshlrev_b32 v129, 16, v65
    v_and_b32 v130, 0xffff0000, v64
    v_lshlrev_b32 v131, 16, v64
    v_and_b32 v132, 0xffff0000, v63
    v_lshlrev_b32 v133, 16, v63
    v_and_b32 v134, 0xffff0000, v62
    v_lshlrev_b32 v135, 16, v62
    v_and_b32 v136, 0xffff0000, v61
    v_lshlrev_b32 v137, 16, v61
    v_and_b32 v138, 0xffff0000, v60
    v_lshlrev_b32 v139, 16, v60
    v_and_b32 v140, 0xffff0000, v59
    v_lshlrev_b32 v141, 16, v59
    v_and_b32 v142, 0xffff0000, v58
    v_lshlrev_b32 v143, 16, v58
    v_and_b32 v144, 0xffff0000, v57
    v_lshlrev_b32 v145, 16, v57
    v_and_b32 v146, 0xffff0000, v56
    v_lshlrev_b32 v147, 16, v56
    v_and_b32 v148, 0xffff0000, v55
    v_lshlrev_b32 v149, 16, v55
    v_and_b32 v150, 0xffff0000, v54
    v_lshlrev_b32 v151, 16, v54
    v_and_b32 v152, 0xffff0000, v53
    v_lshlrev_b32 v153, 16, v53
    v_and_b32 v154, 0xffff0000, v52
    v_lshlrev_b32 v155, 16, v52
    v_and_b32 v156, 0xffff0000, v51
    v_lshlrev_b32 v157, 16, v51
    v_and_b32 v158, 0xffff0000, v50
    v_add_f32 v145, v145, v144
    v_add_f32 v142, v142, v143
    v_add_f32 v146, v146, v145
    v_add_f32 v141, v141, v142
    v_add_f32 v147, v147, v146
    v_add_f32 v140, v140, v141
    v_add_f32 v148, v148, v147
    v_add_f32 v139, v139, v140
    v_add_f32 v149, v149, v148
    v_add_f32 v138, v138, v139
    v_add_f32 v150, v150, v149
    v_add_f32 v137, v137, v138
    v_add_f32 v151, v151, v150
    v_add_f32 v136, v136, v137
    v_add_f32 v152, v152, v151
    v_add_f32 v135, v135, v136
    v_add_f32 v153, v153, v152
    v_add_f32 v134, v134, v135
    v_add_f32 v154, v154, v153
    v_add_f32 v133, v133, v134
    v_add_f32 v155, v155, v154
    v_add_f32 v132, v132, v133
    v_add_f32 v156, v156, v155
    v_add_f32 v131, v131, v132
    v_add_f32 v157, v157, v156
    v_add_f32 v130, v130, v131
    v_add_f32 v158, v158, v157
    v_add_f32 v129, v129, v130
    v_add_f32 v128, v128, v129
    v_sub_f32 v160, v128, v137
    v_mov_b32 v176, v137
    v_sub_f32 v161, v129, v138
    v_add_f32 v177, v138, v144
    v_sub_f32 v162, v130, v139
    v_add_f32 v178, v139, v145
    v_sub_f32 v163, v131, v140
    v_add_f32 v179, v140, v146
    v_sub_f32 v164, v132, v141
    v_add_f32 v180, v141, v147
    v_sub_f32 v165, v133, v142
    v_add_f32 v181, v142, v148
    v_sub_f32 v166, v134, v143
    v_add_f32 v182, v143, v149
    v_mov_b32 v167, v135
    v_mov_b32 v183, v150
    v_add_f32 v168, v136, v144
    v_sub_f32 v184, v151, v144
    v_add_f32 v169, v137, v145
    v_sub_f32 v185, v152, v145
    v_add_f32 v170, v138, v146
    v_sub_f32 v186, v153, v146
    v_add_f32 v171, v139, v147
    v_sub_f32 v187, v154, v147
    v_add_f32 v172, v140, v148
    v_sub_f32 v188, v155, v148
    v_add_f32 v173, v141, v149
    v_sub_f32 v189, v156, v149
    v_add_f32 v174, v142, v150
    v_sub_f32 v190, v157, v150
    v_add_f32 v175, v143, v151
    v_sub_f32 v191, v158, v151
    v_cvt_pk_bf16_f32 v192, v160, v176
    v_cvt_pk_bf16_f32 v193, v161, v177
    v_cvt_pk_bf16_f32 v194, v162, v178
    v_cvt_pk_bf16_f32 v195, v163, v179
    v_cvt_pk_bf16_f32 v196, v164, v180
    v_cvt_pk_bf16_f32 v197, v165, v181
    v_cvt_pk_bf16_f32 v198, v166, v182
    v_cvt_pk_bf16_f32 v199, v167, v183
    v_cvt_pk_bf16_f32 v200, v168, v184
    v_cvt_pk_bf16_f32 v201, v169, v185
    v_cvt_pk_bf16_f32 v202, v170, v186
    v_cvt_pk_bf16_f32 v203, v171, v187
    v_cvt_pk_bf16_f32 v204, v172, v188
    v_cvt_pk_bf16_f32 v205, v173, v189
    v_cvt_pk_bf16_f32 v206, v174, v190
    v_cvt_pk_bf16_f32 v207, v175, v191
    ds_write_addtid_b32 v192 offset:55072
    ds_write_addtid_b32 v193 offset:55344
    ds_write_addtid_b32 v194 offset:55616
    ds_write_addtid_b32 v195 offset:55888
    ds_write_addtid_b32 v196 offset:56160
    ds_write_addtid_b32 v197 offset:56432
    ds_write_addtid_b32 v198 offset:56704
    ds_write_addtid_b32 v199 offset:56976
    ds_write_addtid_b32 v200 offset:57248
    ds_write_addtid_b32 v201 offset:57520
    ds_write_addtid_b32 v202 offset:57792
    ds_write_addtid_b32 v203 offset:58064
    ds_write_addtid_b32 v204 offset:58336
    ds_write_addtid_b32 v205 offset:58608
    ds_write_addtid_b32 v206 offset:58880
    ds_write_addtid_b32 v207 offset:59152
    s_waitcnt vmcnt(0)
    v_perm_b32 v40, v124, v126, s48
    v_perm_b32 v41, v120, v122, s48
    ds_write_b64 v4, v[40:41] offset:0
    v_perm_b32 v42, v124, v126, s49
    v_perm_b32 v43, v120, v122, s49
    ds_write_b64 v4, v[42:43] offset:13040
    v_perm_b32 v44, v125, v127, s48
    v_perm_b32 v45, v121, v123, s48
    ds_write_b64 v4, v[44:45] offset:26080
    v_perm_b32 v46, v125, v127, s49
    v_perm_b32 v47, v121, v123, s49
    ds_write_b64 v4, v[46:47] offset:39120
    v_mov_b32 v39, 3
    ds_write_b32 v0, v39 offset:0
    s_setprio 0
    ds_read_b32 v39, v79 offset:0
    s_waitcnt lgkmcnt(0)
    v_cmp_gt_u32 vcc, 2, v39
    s_nop 0
    s_and_b32 s46, vcc_lo, 15
    s_cbranch_scc0 Lp_32
Lp_31:
    s_sleep 1
    ds_read_b32 v39, v79 offset:0
    s_waitcnt lgkmcnt(0)
    v_cmp_gt_u32 vcc, 2, v39
    s_nop 0
    s_and_b32 s46, vcc_lo, 15
    s_cbranch_scc1 Lp_31
Lp_32:
    ds_read_b64_tr_b16 v[28:29], v6 offset:0
    s_waitcnt lgkmcnt(0)
    global_store_dwordx2 v7, v[28:29], s[34:35]
    v_add_u32 v7, 655360, v7
    ds_read_b32 v39, v79 offset:0
    s_waitcnt lgkmcnt(0)
    v_cmp_gt_u32 vcc, 3, v39
    s_nop 0
    s_and_b32 s46, vcc_lo, 15
    s_cbranch_scc0 Lp_34
Lp_33:
    s_sleep 1
    ds_read_b32 v39, v79 offset:0
    s_waitcnt lgkmcnt(0)
    v_cmp_gt_u32 vcc, 3, v39
    s_nop 0
    s_and_b32 s46, vcc_lo, 15
    s_cbranch_scc1 Lp_33
Lp_34:
    ds_read_b64_tr_b16 v[30:31], v6 offset:2304
    s_waitcnt lgkmcnt(0)
    global_store_dwordx2 v7, v[30:31], s[34:35]
    v_add_u32 v7, 655360, v7
    ds_read_b32 v39, v79 offset:0
    s_waitcnt lgkmcnt(0)
    v_cmp_gt_u32 vcc, 4, v39
    s_nop 0
    s_and_b32 s46, vcc_lo, 15
    s_cbranch_scc0 Lp_36
Lp_35:
    s_sleep 1
    ds_read_b32 v39, v79 offset:0
    s_waitcnt lgkmcnt(0)
    v_cmp_gt_u32 vcc, 4, v39
    s_nop 0
    s_and_b32 s46, vcc_lo, 15
    s_cbranch_scc1 Lp_35
Lp_36:
    ds_read_b64_tr_b16 v[28:29], v6 offset:4608
    s_waitcnt lgkmcnt(0)
    global_store_dwordx2 v7, v[28:29], s[34:35]
    v_add_u32 v7, 655360, v7
    ds_read_b32 v39, v79 offset:0
    s_waitcnt lgkmcnt(0)
    v_cmp_gt_u32 vcc, 5, v39
    s_nop 0
    s_and_b32 s46, vcc_lo, 15
    s_cbranch_scc0 Lp_38
Lp_37:
    s_sleep 1
    ds_read_b32 v39, v79 offset:0
    s_waitcnt lgkmcnt(0)
    v_cmp_gt_u32 vcc, 5, v39
    s_nop 0
    s_and_b32 s46, vcc_lo, 15
    s_cbranch_scc1 Lp_37
Lp_38:
    ds_read_b64_tr_b16 v[30:31], v6 offset:6912
    s_waitcnt lgkmcnt(0)
    global_store_dwordx2 v7, v[30:31], s[34:35]
    v_add_u32 v7, 655360, v7
    ds_read_b32 v39, v79 offset:0
    s_waitcnt lgkmcnt(0)
    v_cmp_gt_u32 vcc, 6, v39
    s_nop 0
    s_and_b32 s46, vcc_lo, 15
    s_cbranch_scc0 Lp_40
Lp_39:
    s_sleep 1
    ds_read_b32 v39, v79 offset:0
    s_waitcnt lgkmcnt(0)
    v_cmp_gt_u32 vcc, 6, v39
    s_nop 0
    s_and_b32 s46, vcc_lo, 15
    s_cbranch_scc1 Lp_39
Lp_40:
    ds_read_b64_tr_b16 v[28:29], v6 offset:9216
    s_waitcnt lgkmcnt(0)
    global_store_dwordx2 v7, v[28:29], s[34:35]
    v_add_u32 v7, 655360, v7
    ds_read_b32 v39, v79 offset:0
    s_waitcnt lgkmcnt(0)
    v_cmp_gt_u32 vcc, 7, v39
    s_nop 0
    s_and_b32 s46, vcc_lo, 15
    s_cbranch_scc0 Lp_42
Lp_41:
    s_sleep 1
    ds_read_b32 v39, v79 offset:0
    s_waitcnt lgkmcnt(0)
    v_cmp_gt_u32 vcc, 7, v39
    s_nop 0
    s_and_b32 s46, vcc_lo, 15
    s_cbranch_scc1 Lp_41
Lp_42:
    ds_read_b64_tr_b16 v[30:31], v6 offset:11520
    s_waitcnt lgkmcnt(0)
    global_store_dwordx2 v7, v[30:31], s[34:35]
    v_add_u32 v7, 655360, v7
    ds_read_b32 v39, v79 offset:0
    s_waitcnt lgkmcnt(0)
    v_cmp_gt_u32 vcc, 8, v39
    s_nop 0
    s_and_b32 s46, vcc_lo, 15
    s_cbranch_scc0 Lp_44
Lp_43:
    s_sleep 1
    ds_read_b32 v39, v79 offset:0
    s_waitcnt lgkmcnt(0)
    v_cmp_gt_u32 vcc, 8, v39
    s_nop 0
    s_and_b32 s46, vcc_lo, 15
    s_cbranch_scc1 Lp_43
Lp_44:
    ds_read_b64_tr_b16 v[28:29], v6 offset:13824
    s_waitcnt lgkmcnt(0)
    global_store_dwordx2 v7, v[28:29], s[34:35]
    v_add_u32 v7, 655360, v7
    ds_read_b32 v39, v79 offset:0
    s_waitcnt lgkmcnt(0)
    v_cmp_gt_u32 vcc, 9, v39
    s_nop 0
    s_and_b32 s46, vcc_lo, 15
    s_cbranch_scc0 Lp_46
Lp_45:
    s_sleep 1
    ds_read_b32 v39, v79 offset:0
    s_waitcnt lgkmcnt(0)
    v_cmp_gt_u32 vcc, 9, v39
    s_nop 0
    s_and_b32 s46, vcc_lo, 15
    s_cbranch_scc1 Lp_45
Lp_46:
    ds_read_b64_tr_b16 v[30:31], v6 offset:16128
    s_waitcnt lgkmcnt(0)
    global_store_dwordx2 v7, v[30:31], s[34:35]
    v_add_u32 v7, 655360, v7
L_fin:
L_end:
    s_endpgm
L_codeend:
.section .rodata,"a"
.p2align 6
.amdhsa_kernel concat_heads__ssm_conv_h3__ssm_conv_s4__prompt_kernel
  .amdhsa_next_free_vgpr 256
  .amdhsa_next_free_sgpr 102
  .amdhsa_accum_offset 256
  .amdhsa_group_segment_fixed_size 0
  .amdhsa_kernarg_size 144
  .amdhsa_user_sgpr_count 2
  .amdhsa_user_sgpr_kernarg_segment_ptr 1
  .amdhsa_system_sgpr_workgroup_id_x 1
.end_amdhsa_kernel
```
